```python
import torch

def _softmax(x, axis=-1):
    return torch.softmax(x, dim=axis)
def _gelu(x):
    return torch.nn.functional.gelu(x, approximate="tanh")
def _silu(x):
    return torch.nn.functional.silu(x)
def _sigmoid(x):
    return torch.sigmoid(x)
def _layernorm(x, axis=-1, eps=1e-5):
    m = x.mean(dim=axis, keepdim=True)
    v = x.var(dim=axis, keepdim=True, unbiased=False)
    return (x - m) / torch.sqrt(v + eps)
def _scatter_add(tgt, idx, src, axis=0):
    return tgt.clone().index_add_(axis, idx, src)
def _segment_sum(src, seg, n):
    out = torch.zeros((n,) + src.shape[1:], dtype=src.dtype)
    return out.index_add_(0, seg, src)
def _pad(x, pw):
    flat = tuple(v for pair in reversed(pw) for v in pair)
    return torch.nn.functional.pad(x, flat)

kernel_name = 'sequential_preLN__linear_attn_block__dense_activation_gelu__prompt'

def setup_inputs():

    _w = (lambda a: (lambda t: t.to(torch.bfloat16) if t.is_floating_point() else t)(torch.as_tensor(a)))
    def _A_setup():
        B, S, D = 1, 2048, 448
        return {
            "x": _w((lambda *s: torch.randn(*s, dtype=torch.bfloat16) * 0.05)(B, S, D)),
            "wqkv": _w((lambda *s: torch.randn(*s, dtype=torch.bfloat16) * 0.1)(D, 3 * D)),
            "wo": _w((lambda *s: torch.randn(*s, dtype=torch.bfloat16) * 0.05)(D, D)),
        }
    _A_in = _A_setup()

    def _B_setup():
        B, S, D, F = 1, 2048, 448, 1792
        return {
            "x": _w((lambda *s: torch.randn(*s, dtype=torch.bfloat16) * 0.05)(B, S, D)),
            "w1": _w((lambda *s: torch.randn(*s, dtype=torch.bfloat16) * 0.8)(D, F) * (D ** -0.5)),
            "b1": _w((lambda *s: torch.randn(*s, dtype=torch.bfloat16) * 12.8)(F) * 0.01),
            "w2": _w((lambda *s: torch.randn(*s, dtype=torch.bfloat16) * 0.4)(F, D) * (F ** -0.5)),
            "b2": _w((lambda *s: torch.randn(*s, dtype=torch.bfloat16) * 6.4)(D) * 0.01),
        }
    _B_in = _B_setup()

    return {
        "A_x": _A_in["x"],
        "A_wqkv": _A_in["wqkv"],
        "A_wo": _A_in["wo"],
        "B_x": _B_in["x"],
        "B_w1": _B_in["w1"],
        "B_b1": _B_in["b1"],
        "B_w2": _B_in["w2"],
        "B_b2": _B_in["b2"],
    }

def reference(A_x, A_wqkv, A_wo, B_x, B_w1, B_b1, B_w2, B_b2):
    def _A_ref(x, wqkv, wo):
        B, S, D = x.shape
        H = 16; Dh = D // H
        qkv = (lambda x, *d: x.permute(*d))((x @ wqkv).reshape(B, S, 3, H, Dh), 2, 0, 3, 1, 4)
        q, k, v = qkv[0], qkv[1], qkv[2]
        phi = lambda t: torch.where(t > 0, t + 1, torch.exp(t)) + 1e-6
        pq, pk = phi(q), phi(k)
        kv = torch.einsum("bhsd,bhse->bhde", pk, v)
        z = torch.einsum("bhsd->bhd", pk)
        num = torch.einsum("bhqd,bhde->bhqe", pq, kv)
        den = torch.einsum("bhqd,bhd->bhq", pq, z)[..., None] + 1e-6
        o = num / den
        return (lambda x, *d: x.permute(*d))(o, 0, 2, 1, 3).reshape(B, S, D) @ wo

    def _B_ref(x, w1, b1, w2, b2):
        h = torch.einsum("bsd,df->bsf", x, w1) + b1
        h = _gelu(h)
        return torch.einsum("bsf,fd->bsd", h, w2) + b2

    x = A_x
    h = x + _A_ref(_layernorm(x, axis=-1), A_wqkv, A_wo)
    h2 = h + _B_ref(_layernorm(h, axis=-1), B_w1, B_b1, B_w2, B_b2)
    return h2
```

```asm
; @launch kernel=k1_kernel grid=(256,1,1) block=(768,1,1) lds=136192
; @launch kernel=k2_kernel grid=(224,1,1) block=(256,1,1) lds=163840
.amdgcn_target "amdgcn-amd-amdhsa--gfx950"
.text
.globl k1_kernel
.p2align 8
.type k1_kernel,@function
k1_kernel:
    s_cmp_ge_u32 s2, 256
    s_cbranch_scc1 K1_DONE
    s_load_dwordx16 s[4:19], s[0:1], 0
    s_load_dwordx4 s[20:23], s[0:1], 64
    s_load_dwordx2 s[24:25], s[0:1], 80
    v_and_b32 v1, 63, v0
    v_lshrrev_b32 v2, 6, v0
    s_nop 0
    v_readfirstlane_b32 s27, v2
    s_nop 0
    s_and_b32 s52, s27, 3
    s_sub_u32 s26, s27, 4
    s_and_b32 s56, s2, 7
    s_lshr_b32 s57, s2, 3
    s_lshl_b32 s58, s56, 1
    s_and_b32 s59, s57, 1
    s_add_u32 s53, s58, s59
    s_lshr_b32 s54, s57, 1
    s_lshr_b32 s55, s54, 1
    s_mul_i32 s55, s55, 1
    s_mul_i32 s59, s59, 3
    s_add_u32 s55, s55, s59
    s_mul_i32 s56, s55, 37
    s_lshr_b32 s56, s56, 8
    s_mul_i32 s56, s56, 7
    s_sub_u32 s55, s55, s56
    s_xor_b32 s69, s54, 1
    s_mul_i32 s72, s52, 4160
    s_mul_i32 s73, s52, 3072
    s_add_u32 s73, s73, 16640
    s_lshl_b32 s83, s52, 12
    v_lshlrev_b32 v41, 4, v1
    s_cmp_ge_u32 s27, 8
    s_cbranch_scc1 K1_TEAM_Q
    s_cmp_ge_u32 s27, 4
    s_cbranch_scc1 K1_TEAM_KV
    s_setprio 3
    s_lshl_b32 s56, s53, 7
    s_lshl_b32 s57, s52, 5
    s_add_u32 s56, s56, s57
    s_movk_i32 s57, 896
    v_lshrrev_b32 v2, 3, v1
    v_bfe_u32 v3, v1, 2, 1
    v_bfe_u32 v5, v1, 4, 1
    v_xor_b32 v3, v3, v5
    v_and_b32 v5, 3, v1
    v_lshl_add_u32 v5, v3, 2, v5
    v_add_u32 v4, s56, v2
    v_mul_lo_u32 v4, v4, s57
    v_lshl_add_u32 v8, v5, 4, v4
    v_add_u32 v9, 6128, v8
    v_add_u32 v10, 12256, v8
    v_add_u32 v11, 18384, v8
    s_mul_i32 s58, s52, 43008
    s_mul_i32 s56, s54, 56
    s_add_u32 s56, s56, s58
    s_mul_i32 s59, s69, 56
    s_add_u32 s59, s59, s58
    v_mov_b32 v2, s56
    v_mov_b32 v3, s59
    s_movk_i32 s58, 2688
    v_add_u32 v4, 0, v1
    v_mul_u32_u24 v5, 43691, v4
    v_lshrrev_b32 v5, 19, v5
    v_mul_u32_u24 v6, 12, v5
    v_sub_u32 v4, v4, v6
    v_mul_lo_u32 v5, v5, s58
    v_cmp_gt_u32 vcc, 4, v4
    v_lshrrev_b32 v6, 2, v4
    v_mul_lo_u32 v6, v6, s57
    v_and_b32 v4, 3, v4
    v_lshl_add_u32 v5, v4, 4, v5
    v_cndmask_b32 v4, v2, v3, vcc
    v_add3_u32 v5, v5, v6, v4
    v_mov_b32 v12, v5
    v_add_u32 v4, 64, v1
    v_mul_u32_u24 v5, 43691, v4
    v_lshrrev_b32 v5, 19, v5
    v_mul_u32_u24 v6, 12, v5
    v_sub_u32 v4, v4, v6
    v_mul_lo_u32 v5, v5, s58
    v_cmp_gt_u32 vcc, 4, v4
    v_lshrrev_b32 v6, 2, v4
    v_mul_lo_u32 v6, v6, s57
    v_and_b32 v4, 3, v4
    v_lshl_add_u32 v5, v4, 4, v5
    v_cndmask_b32 v4, v2, v3, vcc
    v_add3_u32 v5, v5, v6, v4
    v_subrev_u32 v13, 1024, v5
    v_add_u32 v4, 128, v1
    v_mul_u32_u24 v5, 43691, v4
    v_lshrrev_b32 v5, 19, v5
    v_mul_u32_u24 v6, 12, v5
    v_sub_u32 v4, v4, v6
    v_mul_lo_u32 v5, v5, s58
    v_cmp_gt_u32 vcc, 4, v4
    v_lshrrev_b32 v6, 2, v4
    v_mul_lo_u32 v6, v6, s57
    v_and_b32 v4, 3, v4
    v_lshl_add_u32 v5, v4, 4, v5
    v_cndmask_b32 v4, v2, v3, vcc
    v_add3_u32 v5, v5, v6, v4
    v_subrev_u32 v14, 2048, v5
    s_waitcnt lgkmcnt(0)
    s_mov_b32 s28, s4
    s_and_b32 s29, s5, 0xffff
    s_mov_b32 s30, 0x1c0000
    s_mov_b32 s31, 0x00020000
    s_mov_b32 s32, s6
    s_and_b32 s33, s7, 0xffff
    s_mov_b32 s34, 0x126000
    s_mov_b32 s35, 0x00020000
    s_mov_b32 s36, s24
    s_and_b32 s37, s25, 0xffff
    s_mov_b32 s38, 0x10ee000
    s_mov_b32 s39, 0x00020000
    s_lshl_b32 s60, s55, 7
    s_mul_i32 s61, s55, 172032
    s_add_u32 m0, s72, 0x0
    s_nop 0
    buffer_load_dwordx4 v8, s[28:31], s60 offen lds
    buffer_load_dwordx4 v9, s[28:31], s60 offen offset:1040 lds
    buffer_load_dwordx4 v10, s[28:31], s60 offen offset:2080 lds
    buffer_load_dwordx4 v11, s[28:31], s60 offen offset:3120 lds
    s_add_u32 m0, s73, 0x0
    s_nop 0
    buffer_load_dwordx4 v12, s[32:35], s61 offen lds
    buffer_load_dwordx4 v13, s[32:35], s61 offen offset:1024 lds
    buffer_load_dwordx4 v14, s[32:35], s61 offen offset:2048 lds
    s_add_u32 s55, s55, 1
    s_cmp_eq_u32 s55, 7
    s_cselect_b32 s55, 0, s55
    s_lshl_b32 s60, s55, 7
    s_mul_i32 s61, s55, 172032
    s_add_u32 m0, s72, 0x7100
    s_nop 0
    buffer_load_dwordx4 v8, s[28:31], s60 offen lds
    buffer_load_dwordx4 v9, s[28:31], s60 offen offset:1040 lds
    buffer_load_dwordx4 v10, s[28:31], s60 offen offset:2080 lds
    buffer_load_dwordx4 v11, s[28:31], s60 offen offset:3120 lds
    s_add_u32 m0, s73, 0x7100
    s_nop 0
    buffer_load_dwordx4 v12, s[32:35], s61 offen lds
    buffer_load_dwordx4 v13, s[32:35], s61 offen offset:1024 lds
    buffer_load_dwordx4 v14, s[32:35], s61 offen offset:2048 lds
    s_add_u32 s55, s55, 1
    s_cmp_eq_u32 s55, 7
    s_cselect_b32 s55, 0, s55
    v_and_b32 v4, 15, v1
    v_mul_u32_u24 v4, 192, v4
    s_add_u32 s56, s73, 56
    v_add_u32 v32, s56, v4
    v_add_u32 v33, 0xe200, v32
    v_mov_b32 v34, 0x3f803f80
    v_mov_b32 v35, 0x3f803f80
    v_lshrrev_b32 v3, 5, v1
    v_bfe_u32 v5, v1, 4, 1
    v_and_b32 v6, 3, v1
    v_and_b32 v4, 1, v1
    v_cmp_eq_u32 vcc, v4, v5
    s_nop 1
    v_cndmask_b32 v36, 0, v34, vcc
    v_cndmask_b32 v37, 0, v34, vcc
    v_cndmask_b32 v38, 0, v34, vcc
    v_cndmask_b32 v39, 0, v34, vcc
    s_waitcnt vmcnt(7)
    ds_write_b64 v32, v[34:35]
    s_waitcnt lgkmcnt(0)
    s_barrier
    s_lshl_b32 s60, s55, 7
    s_mul_i32 s61, s55, 172032
    s_add_u32 m0, s72, 0xe200
    s_nop 0
    buffer_load_dwordx4 v8, s[28:31], s60 offen lds
    buffer_load_dwordx4 v9, s[28:31], s60 offen offset:1040 lds
    buffer_load_dwordx4 v10, s[28:31], s60 offen offset:2080 lds
    buffer_load_dwordx4 v11, s[28:31], s60 offen offset:3120 lds
    s_add_u32 m0, s73, 0xe200
    s_nop 0
    buffer_load_dwordx4 v12, s[32:35], s61 offen lds
    buffer_load_dwordx4 v13, s[32:35], s61 offen offset:1024 lds
    buffer_load_dwordx4 v14, s[32:35], s61 offen offset:2048 lds
    s_add_u32 s55, s55, 1
    s_cmp_eq_u32 s55, 7
    s_cselect_b32 s55, 0, s55
    s_mov_b32 s40, s22
    s_and_b32 s41, s23, 0xffff
    s_mov_b32 s42, 0x100
    s_mov_b32 s43, 0x00020000
    v_mov_b32 v44, 0
    v_mov_b32 v45, 0
    v_mov_b32 v46, 0
    v_mov_b32 v47, 0
    s_lshl_b32 s56, s53, 4
    s_add_u32 s56, s56, s54
    s_lshl_b32 s57, s56, 12
    s_cmp_lt_u32 s56, 40
    s_cselect_b32 s57, s57, 0x7f000000
    v_and_b32 v2, 255, v0
    v_lshlrev_b32 v2, 4, v2
    buffer_store_dwordx4 v[44:47], v2, s[36:39], s57 offen sc1
    s_mov_b32 s48, s14
    s_and_b32 s49, s15, 0xffff
    s_mov_b32 s50, 0xe00
    s_mov_b32 s51, 0x00020000
    s_lshl_b32 s79, s53, 4
    s_add_u32 s79, s79, s54
    s_lshr_b32 s79, s79, 1
    s_mov_b32 s64, 2
    s_cmp_lt_u32 s79, 112
    s_cselect_b32 s64, 1, s64
    s_cmp_lt_u32 s79, 56
    s_cselect_b32 s64, 0, s64
    s_mov_b32 s44, s8
    s_mov_b32 s45, s9
    s_mov_b32 s46, 0x62000
    s_movk_i32 s63, 64
    s_movk_i32 s65, 896
    s_cmp_eq_u32 s64, 1
    s_cselect_b32 s44, s16, s44
    s_cselect_b32 s45, s17, s45
    s_cselect_b32 s46, 0x188000, s46
    s_cselect_b32 s63, 0x3800, s63
    s_cmp_eq_u32 s64, 0
    s_cselect_b32 s44, s12, s44
    s_cselect_b32 s45, s13, s45
    s_cselect_b32 s46, 0x188000, s46
    s_cselect_b32 s63, 0xe000, s63
    s_cselect_b32 s65, 0xe00, s65
    s_and_b32 s45, s45, 0xffff
    s_mov_b32 s47, 0x00020000
    s_and_b32 s12, s54, 1
    s_sub_u32 s68, s79, 112
    s_mov_b32 s67, s12
    s_mul_i32 s62, s68, 25088
    s_mul_i32 s56, s12, 14336
    s_add_u32 s62, s62, s56
    s_sub_u32 s56, s79, 56
    s_lshr_b32 s57, s56, 3
    s_lshl_b32 s57, s57, 1
    s_add_u32 s57, s57, s12
    s_and_b32 s56, s56, 7
    s_mul_i32 s58, s56, 200704
    s_lshl_b32 s59, s57, 6
    s_add_u32 s58, s58, s59
    s_cmp_eq_u32 s64, 1
    s_cselect_b32 s68, s57, s68
    s_cselect_b32 s67, s56, s67
    s_cselect_b32 s62, s58, s62
    s_lshr_b32 s57, s79, 1
    s_lshl_b32 s57, s57, 1
    s_add_u32 s57, s57, s12
    s_and_b32 s56, s79, 1
    s_mul_i32 s58, s56, 802816
    s_lshl_b32 s59, s57, 6
    s_add_u32 s58, s58, s59
    s_cmp_eq_u32 s64, 0
    s_cselect_b32 s68, s57, s68
    s_cselect_b32 s67, s56, s67
    s_cselect_b32 s62, s58, s62
    s_mul_i32 s56, s52, s63
    s_add_u32 s8, s56, s62
    s_lshl_b32 s10, s68, 6
    s_mul_i32 s56, s68, 29696
    s_add_u32 s56, s56, 0xd7000
    s_cmp_eq_u32 s64, 0
    s_cselect_b32 s9, s56, 0x7f000000
    s_lshl_b32 s63, s63, 2
    s_waitcnt vmcnt(8)
    ds_write_b64 v32, v[34:35] offset:28928
    s_waitcnt lgkmcnt(0)
    s_barrier
    s_lshl_b32 s60, s55, 7
    s_mul_i32 s61, s55, 172032
    s_add_u32 m0, s72, 0x15300
    s_nop 0
    buffer_load_dwordx4 v8, s[28:31], s60 offen lds
    buffer_load_dwordx4 v9, s[28:31], s60 offen offset:1040 lds
    buffer_load_dwordx4 v10, s[28:31], s60 offen offset:2080 lds
    buffer_load_dwordx4 v11, s[28:31], s60 offen offset:3120 lds
    s_add_u32 m0, s73, 0x15300
    s_nop 0
    buffer_load_dwordx4 v12, s[32:35], s61 offen lds
    buffer_load_dwordx4 v13, s[32:35], s61 offen offset:1024 lds
    buffer_load_dwordx4 v14, s[32:35], s61 offen offset:2048 lds
    s_add_u32 s55, s55, 1
    s_cmp_eq_u32 s55, 7
    s_cselect_b32 s55, 0, s55
    s_add_u32 s80, s52, 0
    s_lshr_b32 s56, s80, 1
    s_lshl_b32 s56, s56, 6
    s_lshl_b32 s57, s68, 2
    s_add_u32 s56, s56, s57
    s_lshl_b32 s57, s67, 1
    s_add_u32 s56, s56, s57
    s_lshr_b32 s57, s68, 2
    s_xor_b32 s57, s57, s80
    s_and_b32 s57, s57, 1
    s_add_u32 s56, s56, s57
    s_add_u32 s56, s56, 384
    s_mul_i32 s66, s67, 14
    s_add_u32 s66, s66, s80
    s_lshr_b32 s57, s68, 1
    s_lshl_b32 s57, s57, 2
    s_and_b32 s58, s66, 3
    s_add_u32 s57, s57, s58
    s_mul_i32 s57, s57, 28
    s_lshr_b32 s58, s66, 3
    s_add_u32 s57, s57, s58
    s_bfe_u32 s58, s66, 0x10002
    s_mul_i32 s58, s58, 14
    s_add_u32 s57, s57, s58
    s_lshl_b32 s57, s57, 1
    s_xor_b32 s58, s68, s66
    s_and_b32 s58, s58, 1
    s_add_u32 s57, s57, s58
    s_add_u32 s57, s57, 2456
    s_cmp_eq_u32 s64, 1
    s_cselect_b32 s56, s57, s56
    s_mul_i32 s57, s68, 29
    s_add_u32 s57, s57, s66
    s_add_u32 s57, s57, 832
    s_cmp_eq_u32 s64, 0
    s_cselect_b32 s56, s57, s56
    s_lshl_b32 s4, s56, 10
    s_add_u32 s80, s52, 4
    s_lshr_b32 s56, s80, 1
    s_lshl_b32 s56, s56, 6
    s_lshl_b32 s57, s68, 2
    s_add_u32 s56, s56, s57
    s_lshl_b32 s57, s67, 1
    s_add_u32 s56, s56, s57
    s_lshr_b32 s57, s68, 2
    s_xor_b32 s57, s57, s80
    s_and_b32 s57, s57, 1
    s_add_u32 s56, s56, s57
    s_add_u32 s56, s56, 384
    s_mul_i32 s66, s67, 14
    s_add_u32 s66, s66, s80
    s_lshr_b32 s57, s68, 1
    s_lshl_b32 s57, s57, 2
    s_and_b32 s58, s66, 3
    s_add_u32 s57, s57, s58
    s_mul_i32 s57, s57, 28
    s_lshr_b32 s58, s66, 3
    s_add_u32 s57, s57, s58
    s_bfe_u32 s58, s66, 0x10002
    s_mul_i32 s58, s58, 14
    s_add_u32 s57, s57, s58
    s_lshl_b32 s57, s57, 1
    s_xor_b32 s58, s68, s66
    s_and_b32 s58, s58, 1
    s_add_u32 s57, s57, s58
    s_add_u32 s57, s57, 2456
    s_cmp_eq_u32 s64, 1
    s_cselect_b32 s56, s57, s56
    s_mul_i32 s57, s68, 29
    s_add_u32 s57, s57, s66
    s_add_u32 s57, s57, 832
    s_cmp_eq_u32 s64, 0
    s_cselect_b32 s56, s57, s56
    s_lshl_b32 s5, s56, 10
    s_waitcnt vmcnt(8)
    ds_write_b64 v33, v[34:35]
    s_waitcnt lgkmcnt(0)
    s_barrier
    s_lshl_b32 s60, s55, 7
    s_mul_i32 s61, s55, 172032
    s_add_u32 m0, s72, 0x0
    s_nop 0
    buffer_load_dwordx4 v8, s[28:31], s60 offen lds
    buffer_load_dwordx4 v9, s[28:31], s60 offen offset:1040 lds
    buffer_load_dwordx4 v10, s[28:31], s60 offen offset:2080 lds
    buffer_load_dwordx4 v11, s[28:31], s60 offen offset:3120 lds
    s_add_u32 m0, s73, 0x0
    s_nop 0
    buffer_load_dwordx4 v12, s[32:35], s61 offen lds
    buffer_load_dwordx4 v13, s[32:35], s61 offen offset:1024 lds
    buffer_load_dwordx4 v14, s[32:35], s61 offen offset:2048 lds
    s_add_u32 s55, s55, 1
    s_cmp_eq_u32 s55, 7
    s_cselect_b32 s55, 0, s55
    s_add_u32 s80, s52, 8
    s_lshr_b32 s56, s80, 1
    s_lshl_b32 s56, s56, 6
    s_lshl_b32 s57, s68, 2
    s_add_u32 s56, s56, s57
    s_lshl_b32 s57, s67, 1
    s_add_u32 s56, s56, s57
    s_lshr_b32 s57, s68, 2
    s_xor_b32 s57, s57, s80
    s_and_b32 s57, s57, 1
    s_add_u32 s56, s56, s57
    s_add_u32 s56, s56, 384
    s_mul_i32 s66, s67, 14
    s_add_u32 s66, s66, s80
    s_lshr_b32 s57, s68, 1
    s_lshl_b32 s57, s57, 2
    s_and_b32 s58, s66, 3
    s_add_u32 s57, s57, s58
    s_mul_i32 s57, s57, 28
    s_lshr_b32 s58, s66, 3
    s_add_u32 s57, s57, s58
    s_bfe_u32 s58, s66, 0x10002
    s_mul_i32 s58, s58, 14
    s_add_u32 s57, s57, s58
    s_lshl_b32 s57, s57, 1
    s_xor_b32 s58, s68, s66
    s_and_b32 s58, s58, 1
    s_add_u32 s57, s57, s58
    s_add_u32 s57, s57, 2456
    s_cmp_eq_u32 s64, 1
    s_cselect_b32 s56, s57, s56
    s_mul_i32 s57, s68, 29
    s_add_u32 s57, s57, s66
    s_add_u32 s57, s57, 832
    s_cmp_eq_u32 s64, 0
    s_cselect_b32 s56, s57, s56
    s_lshl_b32 s6, s56, 10
    s_add_u32 s80, s52, 12
    s_lshr_b32 s56, s80, 1
    s_lshl_b32 s56, s56, 6
    s_lshl_b32 s57, s68, 2
    s_add_u32 s56, s56, s57
    s_lshl_b32 s57, s67, 1
    s_add_u32 s56, s56, s57
    s_lshr_b32 s57, s68, 2
    s_xor_b32 s57, s57, s80
    s_and_b32 s57, s57, 1
    s_add_u32 s56, s56, s57
    s_add_u32 s56, s56, 384
    s_mul_i32 s66, s67, 14
    s_add_u32 s66, s66, s80
    s_lshr_b32 s57, s68, 1
    s_lshl_b32 s57, s57, 2
    s_and_b32 s58, s66, 3
    s_add_u32 s57, s57, s58
    s_mul_i32 s57, s57, 28
    s_lshr_b32 s58, s66, 3
    s_add_u32 s57, s57, s58
    s_bfe_u32 s58, s66, 0x10002
    s_mul_i32 s58, s58, 14
    s_add_u32 s57, s57, s58
    s_lshl_b32 s57, s57, 1
    s_xor_b32 s58, s68, s66
    s_and_b32 s58, s58, 1
    s_add_u32 s57, s57, s58
    s_add_u32 s57, s57, 2456
    s_cmp_eq_u32 s64, 1
    s_cselect_b32 s56, s57, s56
    s_mul_i32 s57, s68, 29
    s_add_u32 s57, s57, s66
    s_add_u32 s57, s57, 832
    s_cmp_eq_u32 s64, 0
    s_cselect_b32 s56, s57, s56
    s_lshl_b32 s7, s56, 10
    s_cmp_lt_u32 s52, 2
    s_cselect_b32 s7, s7, 0x7f000000
    s_waitcnt vmcnt(7)
    ds_write_b64 v33, v[34:35] offset:28928
    s_waitcnt lgkmcnt(0)
    s_barrier
    s_lshl_b32 s60, s55, 7
    s_mul_i32 s61, s55, 172032
    s_add_u32 m0, s72, 0x7100
    s_nop 0
    buffer_load_dwordx4 v8, s[28:31], s60 offen lds
    buffer_load_dwordx4 v9, s[28:31], s60 offen offset:1040 lds
    buffer_load_dwordx4 v10, s[28:31], s60 offen offset:2080 lds
    buffer_load_dwordx4 v11, s[28:31], s60 offen offset:3120 lds
    s_add_u32 m0, s73, 0x7100
    s_nop 0
    buffer_load_dwordx4 v12, s[32:35], s61 offen lds
    buffer_load_dwordx4 v13, s[32:35], s61 offen offset:1024 lds
    buffer_load_dwordx4 v14, s[32:35], s61 offen offset:2048 lds
    s_add_u32 s55, s55, 1
    s_cmp_eq_u32 s55, 7
    s_cselect_b32 s55, 0, s55
    s_lshl_b32 s56, s54, 2
    s_cmp_eq_u32 s53, 0
    s_cselect_b32 s56, s56, 0x7f000000
    s_cmp_eq_u32 s52, 0
    s_cselect_b32 s56, s56, 0x7f000000
    v_mov_b32 v2, 1
    v_mov_b32 v4, 0
    buffer_store_dword v2, v4, s[40:43], s56 offen sc1
    v_lshrrev_b32 v3, 5, v1
    v_bfe_u32 v5, v1, 4, 1
    v_and_b32 v6, 3, v1
    v_bfe_u32 v4, v1, 2, 2
    v_lshl_add_u32 v4, v3, 2, v4
    v_lshlrev_b32 v4, 6, v4
    v_lshl_add_u32 v4, v5, 5, v4
    v_lshl_add_u32 v4, v6, 3, v4
    s_add_u32 s56, s83, 0x1c400
    v_add_u32 v40, s56, v4
    v_cmp_eq_u32 s[20:21], 1, v5
    v_lshrrev_b32 v2, 2, v1
    v_mul_lo_u32 v5, v2, s65
    v_lshl_add_u32 v5, v6, 4, v5
    s_lshl_b32 s56, s64, 1
    s_add_u32 s56, s56, s12
    s_cmp_eq_u32 s56, 5
    s_cselect_b32 s59, 12, 64
    v_cmp_gt_u32 vcc, s59, v2
    v_mov_b32 v4, 0x7f000000
    s_nop 0
    v_cndmask_b32 v15, v4, v5, vcc
    v_and_b32 v2, 31, v1
    v_lshlrev_b32 v114, 1, v2
    v_lshlrev_b32 v6, 2, v2
    v_add_u32 v113, 0x21000, v6
    v_mov_b32 v112, 0x21080
    v_cmp_eq_u32 vcc, s67, v3
    s_nop 1
    v_cndmask_b32 v115, v4, v41, vcc
    s_cmp_eq_u32 s67, 0
    s_cselect_b32 s11, -1, 0
    s_waitcnt vmcnt(8)
    ds_write_b64 v32, v[34:35]
    s_waitcnt lgkmcnt(0)
    s_barrier
    s_lshl_b32 s60, s55, 7
    s_mul_i32 s61, s55, 172032
    s_add_u32 m0, s72, 0xe200
    s_nop 0
    buffer_load_dwordx4 v8, s[28:31], s60 offen lds
    buffer_load_dwordx4 v9, s[28:31], s60 offen offset:1040 lds
    buffer_load_dwordx4 v10, s[28:31], s60 offen offset:2080 lds
    buffer_load_dwordx4 v11, s[28:31], s60 offen offset:3120 lds
    s_add_u32 m0, s73, 0xe200
    s_nop 0
    buffer_load_dwordx4 v12, s[32:35], s61 offen lds
    buffer_load_dwordx4 v13, s[32:35], s61 offen offset:1024 lds
    buffer_load_dwordx4 v14, s[32:35], s61 offen offset:2048 lds
    s_add_u32 s55, s55, 1
    s_cmp_eq_u32 s55, 7
    s_cselect_b32 s55, 0, s55
    s_add_u32 m0, s83, 0x1c400
    s_nop 0
    buffer_load_dwordx4 v15, s[44:47], s8 offen lds
    s_add_u32 s8, s8, s63
    s_add_u32 m0, s83, 0x1c800
    s_nop 0
    buffer_load_dwordx4 v15, s[44:47], s8 offen lds
    s_add_u32 s8, s8, s63
    s_add_u32 m0, s83, 0x1cc00
    s_nop 0
    buffer_load_dwordx4 v15, s[44:47], s8 offen lds
    s_add_u32 s8, s8, s63
    s_cmp_lt_u32 s52, 2
    s_cselect_b32 s8, s8, 0x7f000000
    s_add_u32 m0, s83, 0x1d000
    s_nop 0
    buffer_load_dwordx4 v15, s[44:47], s8 offen lds
    buffer_load_ushort v42, v114, s[48:51], s10 offen
    ds_write_b32 v113, v44
    ds_write_b32 v113, v44 offset:128
    s_waitcnt vmcnt(13)
    ds_write_b64 v32, v[34:35] offset:28928
    s_waitcnt lgkmcnt(0)
    s_barrier
    s_waitcnt vmcnt(5)
    ds_write_b64 v33, v[34:35]
    s_waitcnt lgkmcnt(0)
    s_barrier
    v_and_b32 v2, 31, v1
    v_lshrrev_b32 v3, 5, v1
    v_lshrrev_b32 v4, 3, v2
    v_mul_u32_u24 v4, 1040, v4
    v_and_b32 v5, 7, v2
    v_lshl_add_u32 v4, v5, 7, v4
    v_lshl_add_u32 v4, v3, 4, v4
    v_bfe_u32 v5, v2, 1, 1
    v_xor_b32 v5, s12, v5
    v_lshl_add_u32 v4, v5, 6, v4
    s_add_u32 s56, s72, 0xe200
    v_add_u32 v4, s56, v4
    ds_read_b128 v[72:75], v4
    ds_read_b128 v[76:79], v4 offset:32
    s_add_u32 s56, s55, 6
    s_cmp_ge_u32 s56, 7
    s_cselect_b32 s57, 7, 0
    s_sub_u32 s56, s56, s57
    s_lshl_b32 s56, s56, 2
    s_lshl_b32 s57, s12, 1
    s_add_u32 s56, s56, s57
    s_lshl_b32 s57, s53, 2
    s_add_u32 s57, s57, s52
    s_mul_i32 s57, s57, 28
    s_add_u32 s56, s56, s57
    s_lshl_b32 s56, s56, 10
    s_add_u32 s56, s56, 0xeae000
    s_waitcnt lgkmcnt(1)
    buffer_store_dwordx4 v[72:75], v41, s[36:39], s56 offen sc1
    s_waitcnt lgkmcnt(0)
    buffer_store_dwordx4 v[76:79], v41, s[36:39], s56 offen offset:1024 sc1
    s_barrier
    s_barrier
    s_waitcnt vmcnt(3)
    ds_read_b64_tr_b16 v[52:53], v40
    ds_read_b64_tr_b16 v[54:55], v40 offset:512
    ds_read_b64_tr_b16 v[56:57], v40 offset:1024
    ds_read_b64_tr_b16 v[58:59], v40 offset:1536
    ds_read_b64_tr_b16 v[60:61], v40 offset:2048
    ds_read_b64_tr_b16 v[62:63], v40 offset:2560
    ds_read_b64_tr_b16 v[64:65], v40 offset:3072
    ds_read_b64_tr_b16 v[66:67], v40 offset:3584
    s_waitcnt lgkmcnt(6)
    buffer_store_dwordx4 v[52:55], v41, s[36:39], s4 offen sc1
    v_mfma_f32_16x16x32_bf16 v[48:51], v[36:39], v[52:55], 0
    s_waitcnt lgkmcnt(4)
    buffer_store_dwordx4 v[56:59], v41, s[36:39], s5 offen sc1
    v_mfma_f32_16x16x32_bf16 v[48:51], v[36:39], v[56:59], v[48:51]
    s_waitcnt lgkmcnt(2)
    buffer_store_dwordx4 v[60:63], v41, s[36:39], s6 offen sc1
    v_mfma_f32_16x16x32_bf16 v[48:51], v[36:39], v[60:63], v[48:51]
    s_waitcnt lgkmcnt(0)
    buffer_store_dwordx4 v[64:67], v41, s[36:39], s7 offen sc1
    v_mfma_f32_16x16x32_bf16 v[48:51], v[36:39], v[64:67], v[48:51]
    s_nop 7
    v_cndmask_b32 v4, v48, v49, s[20:21]
    s_mov_b32 exec_hi, 0
    ds_add_f32 v113, v4
    v_mov_b32 v5, 1
    s_waitcnt lgkmcnt(0)
    s_mov_b64 exec, 1
    ds_add_rtn_u32 v3, v112, v5
    s_mov_b64 exec, -1
    s_waitcnt lgkmcnt(0)
    v_readfirstlane_b32 s57, v3
    s_nop 0
    s_cmp_eq_u32 s57, 3
    s_cselect_b32 s9, s9, 0x7f000000
    ds_read_b32 v116, v113
    s_waitcnt vmcnt(6)
    v_lshlrev_b32 v123, 16, v42
    v_and_b32 v123, s11, v123
    s_waitcnt lgkmcnt(0)
    v_cvt_pk_bf16_f32 v117, v116, v116
    v_lshlrev_b32 v117, 16, v117
    v_sub_f32 v117, v116, v117
    v_cvt_pk_bf16_f32 v120, v116, v117
    v_cvt_pk_bf16_f32 v121, v116, v123
    v_lshrrev_b32 v122, 16, v123
    v_mov_b32 v123, 0
    buffer_store_dwordx4 v[120:123], v115, s[36:39], s9 offen sc1
    s_endpgm
K1_TEAM_Q:
    v_and_b32 v2, 31, v1
    v_lshrrev_b32 v3, 5, v1
    v_lshrrev_b32 v4, 3, v2
    v_mul_u32_u24 v4, 1040, v4
    v_and_b32 v5, 7, v2
    v_lshl_add_u32 v4, v5, 7, v4
    v_lshl_add_u32 v4, v3, 4, v4
    v_add_u32 v4, s72, v4
    v_bfe_u32 v5, v2, 1, 1
    s_add_u32 s56, s52, 0
    s_bfe_u32 s57, s56, 0x10001
    s_and_b32 s56, s56, 1
    s_lshl_b32 s56, s56, 5
    v_xor_b32 v6, s57, v5
    v_lshl_add_u32 v6, v6, 6, v4
    v_add_u32 v16, s56, v6
    v_add_u32 v20, 0xe200, v16
    s_add_u32 s56, s52, 1
    s_bfe_u32 s57, s56, 0x10001
    s_and_b32 s56, s56, 1
    s_lshl_b32 s56, s56, 5
    v_xor_b32 v6, s57, v5
    v_lshl_add_u32 v6, v6, 6, v4
    v_add_u32 v17, s56, v6
    v_add_u32 v21, 0xe200, v17
    s_add_u32 s56, s52, 2
    s_bfe_u32 s57, s56, 0x10001
    s_and_b32 s56, s56, 1
    s_lshl_b32 s56, s56, 5
    v_xor_b32 v6, s57, v5
    v_lshl_add_u32 v6, v6, 6, v4
    v_add_u32 v18, s56, v6
    v_add_u32 v22, 0xe200, v18
    s_add_u32 s56, s52, 3
    s_bfe_u32 s57, s56, 0x10001
    s_and_b32 s56, s56, 1
    s_lshl_b32 s56, s56, 5
    v_xor_b32 v6, s57, v5
    v_lshl_add_u32 v6, v6, 6, v4
    v_add_u32 v19, s56, v6
    v_add_u32 v23, 0xe200, v19
    v_bfe_u32 v4, v1, 2, 2
    v_lshl_add_u32 v4, v3, 3, v4
    v_mul_u32_u24 v4, 192, v4
    v_bfe_u32 v5, v1, 4, 1
    v_lshl_add_u32 v4, v5, 5, v4
    v_and_b32 v6, 3, v1
    v_lshl_add_u32 v4, v6, 3, v4
    s_add_u32 s56, s52, 0
    s_and_b32 s56, s56, 3
    s_mul_i32 s56, s56, 3072
    s_add_u32 s56, s56, 16640
    v_add_u32 v24, s56, v4
    v_add_u32 v28, 0xe200, v24
    s_add_u32 s56, s52, 1
    s_and_b32 s56, s56, 3
    s_mul_i32 s56, s56, 3072
    s_add_u32 s56, s56, 16640
    v_add_u32 v25, s56, v4
    v_add_u32 v29, 0xe200, v25
    s_add_u32 s56, s52, 2
    s_and_b32 s56, s56, 3
    s_mul_i32 s56, s56, 3072
    s_add_u32 s56, s56, 16640
    v_add_u32 v26, s56, v4
    v_add_u32 v30, 0xe200, v26
    s_add_u32 s56, s52, 3
    s_and_b32 s56, s56, 3
    s_mul_i32 s56, s56, 3072
    s_add_u32 s56, s56, 16640
    v_add_u32 v27, s56, v4
    v_add_u32 v31, 0xe200, v27
    v_mov_b32 v34, 0x3f803f80
    v_mov_b32 v35, 0x3f803f80
    v_and_b32 v4, 1, v1
    v_cmp_eq_u32 vcc, v4, v5
    s_nop 1
    v_cndmask_b32 v36, 0, v34, vcc
    v_cndmask_b32 v37, 0, v34, vcc
    v_cndmask_b32 v38, 0, v34, vcc
    v_cndmask_b32 v39, 0, v34, vcc
    s_mov_b32 s74, 0x358637bd
    s_mov_b32 s75, 0x358637bd
    s_mov_b32 s76, 0x3fb8aa3b
    s_mov_b32 s77, 0x3fb8aa3b
    s_waitcnt lgkmcnt(0)
    s_mov_b32 s36, s24
    s_and_b32 s37, s25, 0xffff
    s_mov_b32 s38, 0x10ee000
    s_mov_b32 s39, 0x00020000
    s_barrier
    ds_read_b128 v[48:51], v16
    ds_read_b64_tr_b16 v[56:57], v24
    ds_read_b64_tr_b16 v[58:59], v24 offset:768
    s_waitcnt lgkmcnt(0)
    v_mfma_f32_32x32x16_bf16 v[72:87], v[56:59], v[48:51], 0
    ds_read_b128 v[52:55], v17
    ds_read_b64_tr_b16 v[64:65], v25
    ds_read_b64_tr_b16 v[66:67], v25 offset:768
    v_mfma_f32_4x4x4_16b_bf16 v[88:91], v[48:49], v[48:49], 0
    v_mfma_f32_4x4x4_16b_bf16 v[92:95], v[50:51], v[50:51], 0
    v_mfma_f32_16x16x32_bf16 v[104:107], v[36:39], v[56:59], 0
    s_waitcnt lgkmcnt(0)
    v_mfma_f32_32x32x16_bf16 v[72:87], v[64:67], v[52:55], v[72:87]
    ds_read_b128 v[48:51], v18
    ds_read_b64_tr_b16 v[56:57], v26
    ds_read_b64_tr_b16 v[58:59], v26 offset:768
    v_mfma_f32_4x4x4_16b_bf16 v[88:91], v[52:53], v[52:53], v[88:91]
    v_mfma_f32_4x4x4_16b_bf16 v[92:95], v[54:55], v[54:55], v[92:95]
    s_waitcnt lgkmcnt(0)
    v_mfma_f32_32x32x16_bf16 v[72:87], v[56:59], v[48:51], v[72:87]
    ds_read_b128 v[52:55], v19
    ds_read_b64_tr_b16 v[64:65], v27
    ds_read_b64_tr_b16 v[66:67], v27 offset:768
    v_mfma_f32_4x4x4_16b_bf16 v[88:91], v[48:49], v[48:49], v[88:91]
    v_mfma_f32_4x4x4_16b_bf16 v[92:95], v[50:51], v[50:51], v[92:95]
    s_waitcnt lgkmcnt(0)
    s_barrier
    v_mfma_f32_32x32x16_bf16 v[72:87], v[64:67], v[52:55], v[72:87]
    ds_read_b128 v[48:51], v16 offset:28928
    ds_read_b64_tr_b16 v[56:57], v24 offset:28928
    ds_read_b64_tr_b16 v[58:59], v24 offset:29696
    v_mfma_f32_4x4x4_16b_bf16 v[88:91], v[52:53], v[52:53], v[88:91]
    v_mfma_f32_4x4x4_16b_bf16 v[92:95], v[54:55], v[54:55], v[92:95]
    s_waitcnt lgkmcnt(0)
    v_mfma_f32_32x32x16_bf16 v[72:87], v[56:59], v[48:51], v[72:87]
    ds_read_b128 v[52:55], v17 offset:28928
    ds_read_b64_tr_b16 v[64:65], v25 offset:28928
    ds_read_b64_tr_b16 v[66:67], v25 offset:29696
    v_mfma_f32_4x4x4_16b_bf16 v[88:91], v[48:49], v[48:49], v[88:91]
    v_mfma_f32_4x4x4_16b_bf16 v[92:95], v[50:51], v[50:51], v[92:95]
    v_mfma_f32_16x16x32_bf16 v[104:107], v[36:39], v[56:59], v[104:107]
    s_waitcnt lgkmcnt(0)
    v_mfma_f32_32x32x16_bf16 v[72:87], v[64:67], v[52:55], v[72:87]
    ds_read_b128 v[48:51], v18 offset:28928
    ds_read_b64_tr_b16 v[56:57], v26 offset:28928
    ds_read_b64_tr_b16 v[58:59], v26 offset:29696
    v_mfma_f32_4x4x4_16b_bf16 v[88:91], v[52:53], v[52:53], v[88:91]
    v_mfma_f32_4x4x4_16b_bf16 v[92:95], v[54:55], v[54:55], v[92:95]
    s_waitcnt lgkmcnt(0)
    v_mfma_f32_32x32x16_bf16 v[72:87], v[56:59], v[48:51], v[72:87]
    ds_read_b128 v[52:55], v19 offset:28928
    ds_read_b64_tr_b16 v[64:65], v27 offset:28928
    ds_read_b64_tr_b16 v[66:67], v27 offset:29696
    v_mfma_f32_4x4x4_16b_bf16 v[88:91], v[48:49], v[48:49], v[88:91]
    v_mfma_f32_4x4x4_16b_bf16 v[92:95], v[50:51], v[50:51], v[92:95]
    s_waitcnt lgkmcnt(0)
    s_barrier
    v_mfma_f32_32x32x16_bf16 v[72:87], v[64:67], v[52:55], v[72:87]
    ds_read_b128 v[48:51], v20
    ds_read_b64_tr_b16 v[56:57], v28
    ds_read_b64_tr_b16 v[58:59], v28 offset:768
    v_mfma_f32_4x4x4_16b_bf16 v[88:91], v[52:53], v[52:53], v[88:91]
    v_mfma_f32_4x4x4_16b_bf16 v[92:95], v[54:55], v[54:55], v[92:95]
    s_waitcnt lgkmcnt(0)
    v_mfma_f32_32x32x16_bf16 v[72:87], v[56:59], v[48:51], v[72:87]
    ds_read_b128 v[52:55], v21
    ds_read_b64_tr_b16 v[64:65], v29
    ds_read_b64_tr_b16 v[66:67], v29 offset:768
    v_mfma_f32_4x4x4_16b_bf16 v[88:91], v[48:49], v[48:49], v[88:91]
    v_mfma_f32_4x4x4_16b_bf16 v[92:95], v[50:51], v[50:51], v[92:95]
    v_mfma_f32_16x16x32_bf16 v[104:107], v[36:39], v[56:59], v[104:107]
    s_waitcnt lgkmcnt(0)
    v_mfma_f32_32x32x16_bf16 v[72:87], v[64:67], v[52:55], v[72:87]
    ds_read_b128 v[48:51], v22
    ds_read_b64_tr_b16 v[56:57], v30
    ds_read_b64_tr_b16 v[58:59], v30 offset:768
    v_mfma_f32_4x4x4_16b_bf16 v[88:91], v[52:53], v[52:53], v[88:91]
    v_mfma_f32_4x4x4_16b_bf16 v[92:95], v[54:55], v[54:55], v[92:95]
    s_waitcnt lgkmcnt(0)
    v_mfma_f32_32x32x16_bf16 v[72:87], v[56:59], v[48:51], v[72:87]
    ds_read_b128 v[52:55], v23
    ds_read_b64_tr_b16 v[64:65], v31
    ds_read_b64_tr_b16 v[66:67], v31 offset:768
    v_mfma_f32_4x4x4_16b_bf16 v[88:91], v[48:49], v[48:49], v[88:91]
    v_mfma_f32_4x4x4_16b_bf16 v[92:95], v[50:51], v[50:51], v[92:95]
    s_waitcnt lgkmcnt(0)
    s_barrier
    v_mfma_f32_32x32x16_bf16 v[72:87], v[64:67], v[52:55], v[72:87]
    ds_read_b128 v[48:51], v20 offset:28928
    ds_read_b64_tr_b16 v[56:57], v28 offset:28928
    ds_read_b64_tr_b16 v[58:59], v28 offset:29696
    v_mfma_f32_4x4x4_16b_bf16 v[88:91], v[52:53], v[52:53], v[88:91]
    v_mfma_f32_4x4x4_16b_bf16 v[92:95], v[54:55], v[54:55], v[92:95]
    s_waitcnt lgkmcnt(0)
    v_mfma_f32_32x32x16_bf16 v[72:87], v[56:59], v[48:51], v[72:87]
    ds_read_b128 v[52:55], v21 offset:28928
    ds_read_b64_tr_b16 v[64:65], v29 offset:28928
    ds_read_b64_tr_b16 v[66:67], v29 offset:29696
    v_mfma_f32_4x4x4_16b_bf16 v[88:91], v[48:49], v[48:49], v[88:91]
    v_mfma_f32_4x4x4_16b_bf16 v[92:95], v[50:51], v[50:51], v[92:95]
    v_mfma_f32_16x16x32_bf16 v[104:107], v[36:39], v[56:59], v[104:107]
    s_waitcnt lgkmcnt(0)
    v_mfma_f32_32x32x16_bf16 v[72:87], v[64:67], v[52:55], v[72:87]
    ds_read_b128 v[48:51], v22 offset:28928
    ds_read_b64_tr_b16 v[56:57], v30 offset:28928
    ds_read_b64_tr_b16 v[58:59], v30 offset:29696
    v_mfma_f32_4x4x4_16b_bf16 v[88:91], v[52:53], v[52:53], v[88:91]
    v_mfma_f32_4x4x4_16b_bf16 v[92:95], v[54:55], v[54:55], v[92:95]
    s_waitcnt lgkmcnt(0)
    v_mfma_f32_32x32x16_bf16 v[72:87], v[56:59], v[48:51], v[72:87]
    ds_read_b128 v[52:55], v23 offset:28928
    ds_read_b64_tr_b16 v[64:65], v31 offset:28928
    ds_read_b64_tr_b16 v[66:67], v31 offset:29696
    v_mfma_f32_4x4x4_16b_bf16 v[88:91], v[48:49], v[48:49], v[88:91]
    v_mfma_f32_4x4x4_16b_bf16 v[92:95], v[50:51], v[50:51], v[92:95]
    s_waitcnt lgkmcnt(0)
    s_barrier
    v_mfma_f32_32x32x16_bf16 v[72:87], v[64:67], v[52:55], v[72:87]
    ds_read_b128 v[48:51], v16
    ds_read_b64_tr_b16 v[56:57], v24
    ds_read_b64_tr_b16 v[58:59], v24 offset:768
    v_mfma_f32_4x4x4_16b_bf16 v[88:91], v[52:53], v[52:53], v[88:91]
    v_mfma_f32_4x4x4_16b_bf16 v[92:95], v[54:55], v[54:55], v[92:95]
    s_waitcnt lgkmcnt(0)
    v_mfma_f32_32x32x16_bf16 v[72:87], v[56:59], v[48:51], v[72:87]
    ds_read_b128 v[52:55], v17
    ds_read_b64_tr_b16 v[64:65], v25
    ds_read_b64_tr_b16 v[66:67], v25 offset:768
    v_mfma_f32_4x4x4_16b_bf16 v[88:91], v[48:49], v[48:49], v[88:91]
    v_mfma_f32_4x4x4_16b_bf16 v[92:95], v[50:51], v[50:51], v[92:95]
    v_mfma_f32_16x16x32_bf16 v[104:107], v[36:39], v[56:59], v[104:107]
    s_waitcnt lgkmcnt(0)
    v_mfma_f32_32x32x16_bf16 v[72:87], v[64:67], v[52:55], v[72:87]
    ds_read_b128 v[48:51], v18
    ds_read_b64_tr_b16 v[56:57], v26
    ds_read_b64_tr_b16 v[58:59], v26 offset:768
    v_mfma_f32_4x4x4_16b_bf16 v[88:91], v[52:53], v[52:53], v[88:91]
    v_mfma_f32_4x4x4_16b_bf16 v[92:95], v[54:55], v[54:55], v[92:95]
    s_waitcnt lgkmcnt(0)
    v_mfma_f32_32x32x16_bf16 v[72:87], v[56:59], v[48:51], v[72:87]
    ds_read_b128 v[52:55], v19
    ds_read_b64_tr_b16 v[64:65], v27
    ds_read_b64_tr_b16 v[66:67], v27 offset:768
    v_mfma_f32_4x4x4_16b_bf16 v[88:91], v[48:49], v[48:49], v[88:91]
    v_mfma_f32_4x4x4_16b_bf16 v[92:95], v[50:51], v[50:51], v[92:95]
    s_waitcnt lgkmcnt(0)
    s_barrier
    v_mfma_f32_32x32x16_bf16 v[72:87], v[64:67], v[52:55], v[72:87]
    ds_read_b128 v[48:51], v16 offset:28928
    ds_read_b64_tr_b16 v[56:57], v24 offset:28928
    ds_read_b64_tr_b16 v[58:59], v24 offset:29696
    v_mfma_f32_4x4x4_16b_bf16 v[88:91], v[52:53], v[52:53], v[88:91]
    v_mfma_f32_4x4x4_16b_bf16 v[92:95], v[54:55], v[54:55], v[92:95]
    s_waitcnt lgkmcnt(0)
    v_mfma_f32_32x32x16_bf16 v[72:87], v[56:59], v[48:51], v[72:87]
    ds_read_b128 v[52:55], v17 offset:28928
    ds_read_b64_tr_b16 v[64:65], v25 offset:28928
    ds_read_b64_tr_b16 v[66:67], v25 offset:29696
    v_mfma_f32_4x4x4_16b_bf16 v[88:91], v[48:49], v[48:49], v[88:91]
    v_mfma_f32_4x4x4_16b_bf16 v[92:95], v[50:51], v[50:51], v[92:95]
    v_mfma_f32_16x16x32_bf16 v[104:107], v[36:39], v[56:59], v[104:107]
    s_waitcnt lgkmcnt(0)
    v_mfma_f32_32x32x16_bf16 v[72:87], v[64:67], v[52:55], v[72:87]
    ds_read_b128 v[48:51], v18 offset:28928
    ds_read_b64_tr_b16 v[56:57], v26 offset:28928
    ds_read_b64_tr_b16 v[58:59], v26 offset:29696
    v_mfma_f32_4x4x4_16b_bf16 v[88:91], v[52:53], v[52:53], v[88:91]
    v_mfma_f32_4x4x4_16b_bf16 v[92:95], v[54:55], v[54:55], v[92:95]
    s_waitcnt lgkmcnt(0)
    v_mfma_f32_32x32x16_bf16 v[72:87], v[56:59], v[48:51], v[72:87]
    ds_read_b128 v[52:55], v19 offset:28928
    ds_read_b64_tr_b16 v[64:65], v27 offset:28928
    ds_read_b64_tr_b16 v[66:67], v27 offset:29696
    v_mfma_f32_4x4x4_16b_bf16 v[88:91], v[48:49], v[48:49], v[88:91]
    v_mfma_f32_4x4x4_16b_bf16 v[92:95], v[50:51], v[50:51], v[92:95]
    s_waitcnt lgkmcnt(0)
    s_barrier
    v_mfma_f32_32x32x16_bf16 v[72:87], v[64:67], v[52:55], v[72:87]
    ds_read_b128 v[48:51], v20
    ds_read_b64_tr_b16 v[56:57], v28
    ds_read_b64_tr_b16 v[58:59], v28 offset:768
    v_mfma_f32_4x4x4_16b_bf16 v[88:91], v[52:53], v[52:53], v[88:91]
    v_mfma_f32_4x4x4_16b_bf16 v[92:95], v[54:55], v[54:55], v[92:95]
    s_waitcnt lgkmcnt(0)
    v_mfma_f32_32x32x16_bf16 v[72:87], v[56:59], v[48:51], v[72:87]
    ds_read_b128 v[52:55], v21
    ds_read_b64_tr_b16 v[64:65], v29
    ds_read_b64_tr_b16 v[66:67], v29 offset:768
    v_mfma_f32_4x4x4_16b_bf16 v[88:91], v[48:49], v[48:49], v[88:91]
    v_mfma_f32_4x4x4_16b_bf16 v[92:95], v[50:51], v[50:51], v[92:95]
    v_mfma_f32_16x16x32_bf16 v[104:107], v[36:39], v[56:59], v[104:107]
    s_waitcnt lgkmcnt(0)
    v_mfma_f32_32x32x16_bf16 v[72:87], v[64:67], v[52:55], v[72:87]
    ds_read_b128 v[48:51], v22
    ds_read_b64_tr_b16 v[56:57], v30
    ds_read_b64_tr_b16 v[58:59], v30 offset:768
    v_mfma_f32_4x4x4_16b_bf16 v[88:91], v[52:53], v[52:53], v[88:91]
    v_mfma_f32_4x4x4_16b_bf16 v[92:95], v[54:55], v[54:55], v[92:95]
    s_waitcnt lgkmcnt(0)
    v_mfma_f32_32x32x16_bf16 v[72:87], v[56:59], v[48:51], v[72:87]
    ds_read_b128 v[52:55], v23
    ds_read_b64_tr_b16 v[64:65], v31
    ds_read_b64_tr_b16 v[66:67], v31 offset:768
    v_mfma_f32_4x4x4_16b_bf16 v[88:91], v[48:49], v[48:49], v[88:91]
    v_mfma_f32_4x4x4_16b_bf16 v[92:95], v[50:51], v[50:51], v[92:95]
    s_waitcnt lgkmcnt(0)
    v_mfma_f32_32x32x16_bf16 v[72:87], v[64:67], v[52:55], v[72:87]
    v_mfma_f32_4x4x4_16b_bf16 v[88:91], v[52:53], v[52:53], v[88:91]
    v_mfma_f32_4x4x4_16b_bf16 v[92:95], v[54:55], v[54:55], v[92:95]
    v_bfe_u32 v5, v1, 4, 1
    v_cmp_eq_u32 vcc, 1, v5
    v_and_b32 v2, 31, v1
    v_mul_u32_u24 v6, 48, v2
    s_lshl_b32 s56, s52, 2
    s_add_u32 s56, s56, 0x20400
    v_add_u32 v4, s56, v6
    v_add_u32 v6, 0x20400, v6
    v_cndmask_b32 v112, v104, v105, vcc
    ds_write_b32 v4, v112
    v_add_f32 v88, v88, v92
    v_add_f32 v89, v89, v93
    v_add_f32 v90, v90, v94
    v_add_f32 v91, v91, v95
    v_and_b32 v3, 3, v1
    v_cmp_eq_u32 vcc, 1, v3
    s_nop 1
    v_cndmask_b32 v122, v88, v89, vcc
    v_cmp_eq_u32 vcc, 2, v3
    s_nop 1
    v_cndmask_b32 v122, v122, v90, vcc
    v_cmp_eq_u32 vcc, 3, v3
    s_nop 1
    v_cndmask_b32 v122, v122, v91, vcc
    v_mov_b32 v123, v122
    v_mov_b32 v117, v122
    s_nop 1
    v_permlane32_swap_b32 v123, v117
    v_add_f32 v117, v117, v123
    v_mov_b32 v123, v84
    v_mov_b32 v116, v84
    s_nop 1
    v_permlane32_swap_b32 v123, v116
    v_mul_f32 v118, 0xbb124925, v116
    v_mul_f32 v117, 0x3b124925, v117
    v_fma_f32 v117, -v118, v118, v117
    v_max_f32 v117, 0, v117
    v_add_f32 v117, 0x3727c5ac, v117
    v_rsq_f32 v120, v117
    v_cvt_pk_bf16_f32 v124, v118, v118
    v_lshlrev_b32 v123, 16, v124
    v_sub_f32 v123, v118, v123
    v_cvt_pk_bf16_f32 v125, v123, 0
    s_lshl_b32 s56, s52, 7
    s_add_u32 s57, s56, 0x20a00
    v_lshl_add_u32 v4, v2, 2, s57
    ds_write_b32 v4, v120
    s_lshl_b32 s56, s52, 8
    s_add_u32 s57, s56, 0x20c00
    v_lshl_add_u32 v4, v2, 3, s57
    ds_write_b64 v4, v[124:125]
    v_mov_b32 v126, 0
    v_mov_b32 v127, 0
    v_mov_b32 v121, v120
    s_waitcnt lgkmcnt(0)
    s_barrier
    ds_read_b128 v[132:135], v6
    v_lshrrev_b32 v3, 5, v1
    v_cmp_eq_u32 vcc, 0, v3
    s_waitcnt lgkmcnt(0)
    v_add_f32 v132, v132, v133
    v_add_f32 v134, v134, v135
    v_add_f32 v132, v132, v134
    v_cndmask_b32 v132, 0, v132, vcc
    v_cvt_pk_bf16_f32 v129, v132, 0
    v_lshlrev_b32 v134, 16, v129
    v_sub_f32 v134, v132, v134
    v_cvt_pk_bf16_f32 v128, v132, v134
    v_mov_b32 v130, 0
    v_mov_b32 v131, 0
    s_nop 1
    v_mfma_f32_32x32x16_bf16 v[72:87], v[128:131], v[124:127], v[72:87]
    s_lshl_b32 s56, s53, 1
    s_lshr_b32 s57, s52, 1
    s_add_u32 s56, s56, s57
    s_lshl_b32 s56, s56, 6
    s_lshl_b32 s57, s69, 2
    s_add_u32 s56, s56, s57
    s_lshr_b32 s57, s69, 3
    s_xor_b32 s57, s57, s52
    s_and_b32 s57, s57, 1
    s_lshl_b32 s57, s57, 1
    s_add_u32 s56, s56, s57
    s_lshl_b32 s56, s56, 10
    s_add_u32 s56, s56, 0x3ee000
    v_pk_fma_f32 v[72:73], v[72:73], v[120:121], s[74:75]
    v_pk_fma_f32 v[74:75], v[74:75], v[120:121], s[74:75]
    v_pk_fma_f32 v[76:77], v[76:77], v[120:121], s[74:75]
    v_pk_fma_f32 v[78:79], v[78:79], v[120:121], s[74:75]
    v_pk_fma_f32 v[80:81], v[80:81], v[120:121], s[74:75]
    v_pk_fma_f32 v[82:83], v[82:83], v[120:121], s[74:75]
    v_pk_fma_f32 v[84:85], v[84:85], v[120:121], s[74:75]
    v_pk_fma_f32 v[86:87], v[86:87], v[120:121], s[74:75]
    v_pk_mul_f32 v[136:137], v[72:73], s[76:77]
    v_pk_mul_f32 v[138:139], v[74:75], s[76:77]
    v_pk_mul_f32 v[140:141], v[76:77], s[76:77]
    v_pk_mul_f32 v[142:143], v[78:79], s[76:77]
    v_pk_mul_f32 v[144:145], v[80:81], s[76:77]
    v_pk_mul_f32 v[146:147], v[82:83], s[76:77]
    v_pk_mul_f32 v[148:149], v[84:85], s[76:77]
    v_pk_mul_f32 v[150:151], v[86:87], s[76:77]
    v_exp_f32 v136, v136 clamp
    v_max_f32 v72, s74, v72
    v_exp_f32 v137, v137 clamp
    v_max_f32 v73, s74, v73
    v_exp_f32 v138, v138 clamp
    v_max_f32 v74, s74, v74
    v_exp_f32 v139, v139 clamp
    v_max_f32 v75, s74, v75
    v_exp_f32 v140, v140 clamp
    v_max_f32 v76, s74, v76
    v_exp_f32 v141, v141 clamp
    v_max_f32 v77, s74, v77
    v_exp_f32 v142, v142 clamp
    v_max_f32 v78, s74, v78
    v_exp_f32 v143, v143 clamp
    v_max_f32 v79, s74, v79
    v_exp_f32 v144, v144 clamp
    v_max_f32 v80, s74, v80
    v_exp_f32 v145, v145 clamp
    v_max_f32 v81, s74, v81
    v_exp_f32 v146, v146 clamp
    v_max_f32 v82, s74, v82
    v_exp_f32 v147, v147 clamp
    v_max_f32 v83, s74, v83
    v_exp_f32 v148, v148 clamp
    v_max_f32 v84, s74, v84
    v_exp_f32 v149, v149 clamp
    v_max_f32 v85, s74, v85
    v_exp_f32 v150, v150 clamp
    v_max_f32 v86, s74, v86
    v_exp_f32 v151, v151 clamp
    v_max_f32 v87, s74, v87
    v_pk_add_f32 v[72:73], v[72:73], v[136:137]
    v_pk_add_f32 v[74:75], v[74:75], v[138:139]
    v_pk_add_f32 v[76:77], v[76:77], v[140:141]
    v_pk_add_f32 v[78:79], v[78:79], v[142:143]
    v_pk_add_f32 v[80:81], v[80:81], v[144:145]
    v_pk_add_f32 v[82:83], v[82:83], v[146:147]
    v_pk_add_f32 v[84:85], v[84:85], v[148:149]
    v_pk_add_f32 v[86:87], v[86:87], v[150:151]
    v_cvt_pk_bf16_f32 v152, v72, v73
    v_cvt_pk_bf16_f32 v153, v74, v75
    v_cvt_pk_bf16_f32 v154, v76, v77
    v_cvt_pk_bf16_f32 v155, v78, v79
    v_cvt_pk_bf16_f32 v156, v80, v81
    v_cvt_pk_bf16_f32 v157, v82, v83
    v_cvt_pk_bf16_f32 v158, v84, v85
    v_cvt_pk_bf16_f32 v159, v86, v87
    buffer_store_dwordx4 v[152:155], v41, s[36:39], s56 offen sc1
    buffer_store_dwordx4 v[156:159], v41, s[36:39], s56 offen offset:1024 sc1
    s_barrier
    s_endpgm
K1_TEAM_KV:
    s_getpc_b64 s[70:71]
K1_PCREF:
    s_sub_u32 s70, s70, K1_PCREF-k1_kernel
    s_subb_u32 s71, s71, 0
    s_lshr_b32 s56, s2, 3
    s_lshl_b32 s56, s56, 2
    s_add_u32 s56, s56, s52
    s_lshl_b32 s56, s56, 8
    v_and_b32 v2, 1, v1
    v_lshl_add_u32 v2, v2, 7, s56
    v_min_u32 v2, K2_END-k1_kernel-4, v2
    global_load_dword v47, v2, s[70:71]
    v_and_b32 v2, 31, v1
    v_lshrrev_b32 v3, 5, v1
    v_lshrrev_b32 v4, 3, v2
    v_mul_u32_u24 v4, 1040, v4
    v_and_b32 v5, 7, v2
    v_lshl_add_u32 v4, v5, 7, v4
    v_lshl_add_u32 v4, v3, 4, v4
    v_add_u32 v4, s72, v4
    v_bfe_u32 v5, v2, 1, 1
    s_add_u32 s56, s52, 0
    s_bfe_u32 s57, s56, 0x10001
    s_and_b32 s56, s56, 1
    s_lshl_b32 s56, s56, 5
    v_xor_b32 v6, s57, v5
    v_lshl_add_u32 v6, v6, 6, v4
    v_add_u32 v16, s56, v6
    v_add_u32 v20, 0xe200, v16
    s_add_u32 s56, s52, 1
    s_bfe_u32 s57, s56, 0x10001
    s_and_b32 s56, s56, 1
    s_lshl_b32 s56, s56, 5
    v_xor_b32 v6, s57, v5
    v_lshl_add_u32 v6, v6, 6, v4
    v_add_u32 v17, s56, v6
    v_add_u32 v21, 0xe200, v17
    s_add_u32 s56, s52, 2
    s_bfe_u32 s57, s56, 0x10001
    s_and_b32 s56, s56, 1
    s_lshl_b32 s56, s56, 5
    v_xor_b32 v6, s57, v5
    v_lshl_add_u32 v6, v6, 6, v4
    v_add_u32 v18, s56, v6
    v_add_u32 v22, 0xe200, v18
    s_add_u32 s56, s52, 3
    s_bfe_u32 s57, s56, 0x10001
    s_and_b32 s56, s56, 1
    s_lshl_b32 s56, s56, 5
    v_xor_b32 v6, s57, v5
    v_lshl_add_u32 v6, v6, 6, v4
    v_add_u32 v19, s56, v6
    v_add_u32 v23, 0xe200, v19
    v_bfe_u32 v4, v1, 2, 2
    v_lshl_add_u32 v4, v3, 3, v4
    v_mul_u32_u24 v4, 192, v4
    v_bfe_u32 v5, v1, 4, 1
    v_lshl_add_u32 v4, v5, 5, v4
    v_and_b32 v6, 3, v1
    v_lshl_add_u32 v4, v6, 3, v4
    s_add_u32 s56, s52, 0
    s_and_b32 s56, s56, 3
    s_mul_i32 s56, s56, 3072
    s_add_u32 s56, s56, 16640
    v_add_u32 v24, s56, v4
    v_add_u32 v28, 0xe200, v24
    s_add_u32 s56, s52, 1
    s_and_b32 s56, s56, 3
    s_mul_i32 s56, s56, 3072
    s_add_u32 s56, s56, 16640
    v_add_u32 v25, s56, v4
    v_add_u32 v29, 0xe200, v25
    s_add_u32 s56, s52, 2
    s_and_b32 s56, s56, 3
    s_mul_i32 s56, s56, 3072
    s_add_u32 s56, s56, 16640
    v_add_u32 v26, s56, v4
    v_add_u32 v30, 0xe200, v26
    s_add_u32 s56, s52, 3
    s_and_b32 s56, s56, 3
    s_mul_i32 s56, s56, 3072
    s_add_u32 s56, s56, 16640
    v_add_u32 v27, s56, v4
    v_add_u32 v31, 0xe200, v27
    v_mov_b32 v34, 0x3f803f80
    v_mov_b32 v35, 0x3f803f80
    v_and_b32 v4, 1, v1
    v_cmp_eq_u32 vcc, v4, v5
    s_nop 1
    v_cndmask_b32 v36, 0, v34, vcc
    v_cndmask_b32 v37, 0, v34, vcc
    v_cndmask_b32 v38, 0, v34, vcc
    v_cndmask_b32 v39, 0, v34, vcc
    s_mov_b32 s74, 0x358637bd
    s_mov_b32 s75, 0x358637bd
    s_mov_b32 s76, 0x3fb8aa3b
    s_mov_b32 s77, 0x3fb8aa3b
    s_waitcnt lgkmcnt(0)
    s_mov_b32 s36, s24
    s_and_b32 s37, s25, 0xffff
    s_mov_b32 s38, 0x10ee000
    s_mov_b32 s39, 0x00020000
    s_mov_b32 s40, s22
    s_and_b32 s41, s23, 0xffff
    s_mov_b32 s42, 0x100
    s_mov_b32 s43, 0x00020000
    s_barrier
    ds_read_b128 v[48:51], v16
    ds_read_b64_tr_b16 v[56:57], v24 offset:64
    ds_read_b64_tr_b16 v[58:59], v24 offset:832
    ds_read_b64_tr_b16 v[60:61], v24 offset:128
    ds_read_b64_tr_b16 v[62:63], v24 offset:896
    s_waitcnt lgkmcnt(2)
    v_mfma_f32_32x32x16_bf16 v[72:87], v[48:51], v[56:59], 0
    ds_read_b128 v[52:55], v17
    ds_read_b64_tr_b16 v[64:65], v25 offset:64
    ds_read_b64_tr_b16 v[66:67], v25 offset:832
    s_waitcnt lgkmcnt(3)
    v_mfma_f32_32x32x16_bf16 v[88:103], v[48:51], v[60:63], 0
    ds_read_b64_tr_b16 v[68:69], v25 offset:128
    ds_read_b64_tr_b16 v[70:71], v25 offset:896
    v_mfma_f32_16x16x32_bf16 v[104:107], v[36:39], v[56:59], 0
    v_mfma_f32_16x16x32_bf16 v[108:111], v[36:39], v[60:63], 0
    s_waitcnt lgkmcnt(2)
    v_mfma_f32_32x32x16_bf16 v[72:87], v[52:55], v[64:67], v[72:87]
    ds_read_b128 v[48:51], v18
    ds_read_b64_tr_b16 v[56:57], v26 offset:64
    ds_read_b64_tr_b16 v[58:59], v26 offset:832
    s_waitcnt lgkmcnt(3)
    v_mfma_f32_32x32x16_bf16 v[88:103], v[52:55], v[68:71], v[88:103]
    ds_read_b64_tr_b16 v[60:61], v26 offset:128
    ds_read_b64_tr_b16 v[62:63], v26 offset:896
    s_waitcnt lgkmcnt(2)
    v_mfma_f32_32x32x16_bf16 v[72:87], v[48:51], v[56:59], v[72:87]
    ds_read_b128 v[52:55], v19
    ds_read_b64_tr_b16 v[64:65], v27 offset:64
    ds_read_b64_tr_b16 v[66:67], v27 offset:832
    s_waitcnt lgkmcnt(3)
    v_mfma_f32_32x32x16_bf16 v[88:103], v[48:51], v[60:63], v[88:103]
    ds_read_b64_tr_b16 v[68:69], v27 offset:128
    ds_read_b64_tr_b16 v[70:71], v27 offset:896
    s_waitcnt lgkmcnt(0)
    s_barrier
    v_mfma_f32_32x32x16_bf16 v[72:87], v[52:55], v[64:67], v[72:87]
    ds_read_b128 v[48:51], v16 offset:28928
    ds_read_b64_tr_b16 v[56:57], v24 offset:28992
    ds_read_b64_tr_b16 v[58:59], v24 offset:29760
    v_mfma_f32_32x32x16_bf16 v[88:103], v[52:55], v[68:71], v[88:103]
    ds_read_b64_tr_b16 v[60:61], v24 offset:29056
    ds_read_b64_tr_b16 v[62:63], v24 offset:29824
    s_waitcnt lgkmcnt(2)
    v_mfma_f32_32x32x16_bf16 v[72:87], v[48:51], v[56:59], v[72:87]
    ds_read_b128 v[52:55], v17 offset:28928
    ds_read_b64_tr_b16 v[64:65], v25 offset:28992
    ds_read_b64_tr_b16 v[66:67], v25 offset:29760
    s_waitcnt lgkmcnt(3)
    v_mfma_f32_32x32x16_bf16 v[88:103], v[48:51], v[60:63], v[88:103]
    ds_read_b64_tr_b16 v[68:69], v25 offset:29056
    ds_read_b64_tr_b16 v[70:71], v25 offset:29824
    v_mfma_f32_16x16x32_bf16 v[104:107], v[36:39], v[56:59], v[104:107]
    v_mfma_f32_16x16x32_bf16 v[108:111], v[36:39], v[60:63], v[108:111]
    s_waitcnt lgkmcnt(2)
    v_mfma_f32_32x32x16_bf16 v[72:87], v[52:55], v[64:67], v[72:87]
    ds_read_b128 v[48:51], v18 offset:28928
    ds_read_b64_tr_b16 v[56:57], v26 offset:28992
    ds_read_b64_tr_b16 v[58:59], v26 offset:29760
    s_waitcnt lgkmcnt(3)
    v_mfma_f32_32x32x16_bf16 v[88:103], v[52:55], v[68:71], v[88:103]
    ds_read_b64_tr_b16 v[60:61], v26 offset:29056
    ds_read_b64_tr_b16 v[62:63], v26 offset:29824
    s_waitcnt lgkmcnt(2)
    v_mfma_f32_32x32x16_bf16 v[72:87], v[48:51], v[56:59], v[72:87]
    ds_read_b128 v[52:55], v19 offset:28928
    ds_read_b64_tr_b16 v[64:65], v27 offset:28992
    ds_read_b64_tr_b16 v[66:67], v27 offset:29760
    s_waitcnt lgkmcnt(3)
    v_mfma_f32_32x32x16_bf16 v[88:103], v[48:51], v[60:63], v[88:103]
    ds_read_b64_tr_b16 v[68:69], v27 offset:29056
    ds_read_b64_tr_b16 v[70:71], v27 offset:29824
    s_waitcnt lgkmcnt(0)
    s_barrier
    v_mfma_f32_32x32x16_bf16 v[72:87], v[52:55], v[64:67], v[72:87]
    ds_read_b128 v[48:51], v20
    ds_read_b64_tr_b16 v[56:57], v28 offset:64
    ds_read_b64_tr_b16 v[58:59], v28 offset:832
    v_mfma_f32_32x32x16_bf16 v[88:103], v[52:55], v[68:71], v[88:103]
    ds_read_b64_tr_b16 v[60:61], v28 offset:128
    ds_read_b64_tr_b16 v[62:63], v28 offset:896
    s_waitcnt lgkmcnt(2)
    v_mfma_f32_32x32x16_bf16 v[72:87], v[48:51], v[56:59], v[72:87]
    ds_read_b128 v[52:55], v21
    ds_read_b64_tr_b16 v[64:65], v29 offset:64
    ds_read_b64_tr_b16 v[66:67], v29 offset:832
    s_waitcnt lgkmcnt(3)
    v_mfma_f32_32x32x16_bf16 v[88:103], v[48:51], v[60:63], v[88:103]
    ds_read_b64_tr_b16 v[68:69], v29 offset:128
    ds_read_b64_tr_b16 v[70:71], v29 offset:896
    v_mfma_f32_16x16x32_bf16 v[104:107], v[36:39], v[56:59], v[104:107]
    v_mfma_f32_16x16x32_bf16 v[108:111], v[36:39], v[60:63], v[108:111]
    s_waitcnt lgkmcnt(2)
    v_mfma_f32_32x32x16_bf16 v[72:87], v[52:55], v[64:67], v[72:87]
    ds_read_b128 v[48:51], v22
    ds_read_b64_tr_b16 v[56:57], v30 offset:64
    ds_read_b64_tr_b16 v[58:59], v30 offset:832
    s_waitcnt lgkmcnt(3)
    v_mfma_f32_32x32x16_bf16 v[88:103], v[52:55], v[68:71], v[88:103]
    ds_read_b64_tr_b16 v[60:61], v30 offset:128
    ds_read_b64_tr_b16 v[62:63], v30 offset:896
    s_waitcnt lgkmcnt(2)
    v_mfma_f32_32x32x16_bf16 v[72:87], v[48:51], v[56:59], v[72:87]
    ds_read_b128 v[52:55], v23
    ds_read_b64_tr_b16 v[64:65], v31 offset:64
    ds_read_b64_tr_b16 v[66:67], v31 offset:832
    s_waitcnt lgkmcnt(3)
    v_mfma_f32_32x32x16_bf16 v[88:103], v[48:51], v[60:63], v[88:103]
    ds_read_b64_tr_b16 v[68:69], v31 offset:128
    ds_read_b64_tr_b16 v[70:71], v31 offset:896
    s_waitcnt lgkmcnt(0)
    s_barrier
    v_mfma_f32_32x32x16_bf16 v[72:87], v[52:55], v[64:67], v[72:87]
    ds_read_b128 v[48:51], v20 offset:28928
    ds_read_b64_tr_b16 v[56:57], v28 offset:28992
    ds_read_b64_tr_b16 v[58:59], v28 offset:29760
    v_mfma_f32_32x32x16_bf16 v[88:103], v[52:55], v[68:71], v[88:103]
    ds_read_b64_tr_b16 v[60:61], v28 offset:29056
    ds_read_b64_tr_b16 v[62:63], v28 offset:29824
    s_waitcnt lgkmcnt(2)
    v_mfma_f32_32x32x16_bf16 v[72:87], v[48:51], v[56:59], v[72:87]
    ds_read_b128 v[52:55], v21 offset:28928
    ds_read_b64_tr_b16 v[64:65], v29 offset:28992
    ds_read_b64_tr_b16 v[66:67], v29 offset:29760
    s_waitcnt lgkmcnt(3)
    v_mfma_f32_32x32x16_bf16 v[88:103], v[48:51], v[60:63], v[88:103]
    ds_read_b64_tr_b16 v[68:69], v29 offset:29056
    ds_read_b64_tr_b16 v[70:71], v29 offset:29824
    v_mfma_f32_16x16x32_bf16 v[104:107], v[36:39], v[56:59], v[104:107]
    v_mfma_f32_16x16x32_bf16 v[108:111], v[36:39], v[60:63], v[108:111]
    s_waitcnt lgkmcnt(2)
    v_mfma_f32_32x32x16_bf16 v[72:87], v[52:55], v[64:67], v[72:87]
    ds_read_b128 v[48:51], v22 offset:28928
    ds_read_b64_tr_b16 v[56:57], v30 offset:28992
    ds_read_b64_tr_b16 v[58:59], v30 offset:29760
    s_waitcnt lgkmcnt(3)
    v_mfma_f32_32x32x16_bf16 v[88:103], v[52:55], v[68:71], v[88:103]
    ds_read_b64_tr_b16 v[60:61], v30 offset:29056
    ds_read_b64_tr_b16 v[62:63], v30 offset:29824
    s_waitcnt lgkmcnt(2)
    v_mfma_f32_32x32x16_bf16 v[72:87], v[48:51], v[56:59], v[72:87]
    ds_read_b128 v[52:55], v23 offset:28928
    ds_read_b64_tr_b16 v[64:65], v31 offset:28992
    ds_read_b64_tr_b16 v[66:67], v31 offset:29760
    s_waitcnt lgkmcnt(3)
    v_mfma_f32_32x32x16_bf16 v[88:103], v[48:51], v[60:63], v[88:103]
    ds_read_b64_tr_b16 v[68:69], v31 offset:29056
    ds_read_b64_tr_b16 v[70:71], v31 offset:29824
    s_waitcnt lgkmcnt(0)
    s_barrier
    v_mfma_f32_32x32x16_bf16 v[72:87], v[52:55], v[64:67], v[72:87]
    ds_read_b128 v[48:51], v16
    ds_read_b64_tr_b16 v[56:57], v24 offset:64
    ds_read_b64_tr_b16 v[58:59], v24 offset:832
    v_mfma_f32_32x32x16_bf16 v[88:103], v[52:55], v[68:71], v[88:103]
    ds_read_b64_tr_b16 v[60:61], v24 offset:128
    ds_read_b64_tr_b16 v[62:63], v24 offset:896
    s_waitcnt lgkmcnt(2)
    v_mfma_f32_32x32x16_bf16 v[72:87], v[48:51], v[56:59], v[72:87]
    ds_read_b128 v[52:55], v17
    ds_read_b64_tr_b16 v[64:65], v25 offset:64
    ds_read_b64_tr_b16 v[66:67], v25 offset:832
    s_waitcnt lgkmcnt(3)
    v_mfma_f32_32x32x16_bf16 v[88:103], v[48:51], v[60:63], v[88:103]
    ds_read_b64_tr_b16 v[68:69], v25 offset:128
    ds_read_b64_tr_b16 v[70:71], v25 offset:896
    v_mfma_f32_16x16x32_bf16 v[104:107], v[36:39], v[56:59], v[104:107]
    v_mfma_f32_16x16x32_bf16 v[108:111], v[36:39], v[60:63], v[108:111]
    s_waitcnt lgkmcnt(2)
    v_mfma_f32_32x32x16_bf16 v[72:87], v[52:55], v[64:67], v[72:87]
    ds_read_b128 v[48:51], v18
    ds_read_b64_tr_b16 v[56:57], v26 offset:64
    ds_read_b64_tr_b16 v[58:59], v26 offset:832
    s_waitcnt lgkmcnt(3)
    v_mfma_f32_32x32x16_bf16 v[88:103], v[52:55], v[68:71], v[88:103]
    ds_read_b64_tr_b16 v[60:61], v26 offset:128
    ds_read_b64_tr_b16 v[62:63], v26 offset:896
    s_waitcnt lgkmcnt(2)
    v_mfma_f32_32x32x16_bf16 v[72:87], v[48:51], v[56:59], v[72:87]
    ds_read_b128 v[52:55], v19
    ds_read_b64_tr_b16 v[64:65], v27 offset:64
    ds_read_b64_tr_b16 v[66:67], v27 offset:832
    s_waitcnt lgkmcnt(3)
    v_mfma_f32_32x32x16_bf16 v[88:103], v[48:51], v[60:63], v[88:103]
    ds_read_b64_tr_b16 v[68:69], v27 offset:128
    ds_read_b64_tr_b16 v[70:71], v27 offset:896
    s_waitcnt lgkmcnt(0)
    s_barrier
    v_mfma_f32_32x32x16_bf16 v[72:87], v[52:55], v[64:67], v[72:87]
    ds_read_b128 v[48:51], v16 offset:28928
    ds_read_b64_tr_b16 v[56:57], v24 offset:28992
    ds_read_b64_tr_b16 v[58:59], v24 offset:29760
    v_mfma_f32_32x32x16_bf16 v[88:103], v[52:55], v[68:71], v[88:103]
    ds_read_b64_tr_b16 v[60:61], v24 offset:29056
    ds_read_b64_tr_b16 v[62:63], v24 offset:29824
    s_waitcnt lgkmcnt(2)
    v_mfma_f32_32x32x16_bf16 v[72:87], v[48:51], v[56:59], v[72:87]
    ds_read_b128 v[52:55], v17 offset:28928
    ds_read_b64_tr_b16 v[64:65], v25 offset:28992
    ds_read_b64_tr_b16 v[66:67], v25 offset:29760
    s_waitcnt lgkmcnt(3)
    v_mfma_f32_32x32x16_bf16 v[88:103], v[48:51], v[60:63], v[88:103]
    ds_read_b64_tr_b16 v[68:69], v25 offset:29056
    ds_read_b64_tr_b16 v[70:71], v25 offset:29824
    v_mfma_f32_16x16x32_bf16 v[104:107], v[36:39], v[56:59], v[104:107]
    v_mfma_f32_16x16x32_bf16 v[108:111], v[36:39], v[60:63], v[108:111]
    s_waitcnt lgkmcnt(2)
    v_mfma_f32_32x32x16_bf16 v[72:87], v[52:55], v[64:67], v[72:87]
    ds_read_b128 v[48:51], v18 offset:28928
    ds_read_b64_tr_b16 v[56:57], v26 offset:28992
    ds_read_b64_tr_b16 v[58:59], v26 offset:29760
    s_waitcnt lgkmcnt(3)
    v_mfma_f32_32x32x16_bf16 v[88:103], v[52:55], v[68:71], v[88:103]
    ds_read_b64_tr_b16 v[60:61], v26 offset:29056
    ds_read_b64_tr_b16 v[62:63], v26 offset:29824
    s_waitcnt lgkmcnt(2)
    v_mfma_f32_32x32x16_bf16 v[72:87], v[48:51], v[56:59], v[72:87]
    ds_read_b128 v[52:55], v19 offset:28928
    ds_read_b64_tr_b16 v[64:65], v27 offset:28992
    ds_read_b64_tr_b16 v[66:67], v27 offset:29760
    s_waitcnt lgkmcnt(3)
    v_mfma_f32_32x32x16_bf16 v[88:103], v[48:51], v[60:63], v[88:103]
    ds_read_b64_tr_b16 v[68:69], v27 offset:29056
    ds_read_b64_tr_b16 v[70:71], v27 offset:29824
    s_waitcnt lgkmcnt(0)
    s_barrier
    v_mfma_f32_32x32x16_bf16 v[72:87], v[52:55], v[64:67], v[72:87]
    ds_read_b128 v[48:51], v20
    ds_read_b64_tr_b16 v[56:57], v28 offset:64
    ds_read_b64_tr_b16 v[58:59], v28 offset:832
    v_mfma_f32_32x32x16_bf16 v[88:103], v[52:55], v[68:71], v[88:103]
    ds_read_b64_tr_b16 v[60:61], v28 offset:128
    ds_read_b64_tr_b16 v[62:63], v28 offset:896
    v_mov_b32 v4, 0
    s_lshl_b32 s81, s54, 2
    buffer_load_dword v43, v4, s[40:43], s81 offen sc1
    s_waitcnt lgkmcnt(2)
    v_mfma_f32_32x32x16_bf16 v[72:87], v[48:51], v[56:59], v[72:87]
    ds_read_b128 v[52:55], v21
    ds_read_b64_tr_b16 v[64:65], v29 offset:64
    ds_read_b64_tr_b16 v[66:67], v29 offset:832
    s_waitcnt lgkmcnt(3)
    v_mfma_f32_32x32x16_bf16 v[88:103], v[48:51], v[60:63], v[88:103]
    ds_read_b64_tr_b16 v[68:69], v29 offset:128
    ds_read_b64_tr_b16 v[70:71], v29 offset:896
    v_mfma_f32_16x16x32_bf16 v[104:107], v[36:39], v[56:59], v[104:107]
    v_mfma_f32_16x16x32_bf16 v[108:111], v[36:39], v[60:63], v[108:111]
    s_waitcnt lgkmcnt(2)
    v_mfma_f32_32x32x16_bf16 v[72:87], v[52:55], v[64:67], v[72:87]
    ds_read_b128 v[48:51], v22
    ds_read_b64_tr_b16 v[56:57], v30 offset:64
    ds_read_b64_tr_b16 v[58:59], v30 offset:832
    s_waitcnt lgkmcnt(3)
    v_mfma_f32_32x32x16_bf16 v[88:103], v[52:55], v[68:71], v[88:103]
    ds_read_b64_tr_b16 v[60:61], v30 offset:128
    ds_read_b64_tr_b16 v[62:63], v30 offset:896
    s_waitcnt lgkmcnt(2)
    v_mfma_f32_32x32x16_bf16 v[72:87], v[48:51], v[56:59], v[72:87]
    ds_read_b128 v[52:55], v23
    ds_read_b64_tr_b16 v[64:65], v31 offset:64
    ds_read_b64_tr_b16 v[66:67], v31 offset:832
    s_waitcnt lgkmcnt(3)
    v_mfma_f32_32x32x16_bf16 v[88:103], v[48:51], v[60:63], v[88:103]
    ds_read_b64_tr_b16 v[68:69], v31 offset:128
    ds_read_b64_tr_b16 v[70:71], v31 offset:896
    s_waitcnt lgkmcnt(2)
    v_mfma_f32_32x32x16_bf16 v[72:87], v[52:55], v[64:67], v[72:87]
    s_waitcnt lgkmcnt(0)
    v_mfma_f32_32x32x16_bf16 v[88:103], v[52:55], v[68:71], v[88:103]
    v_bfe_u32 v5, v1, 4, 1
    v_cmp_eq_u32 vcc, 1, v5
    v_and_b32 v2, 31, v1
    v_mul_u32_u24 v6, 48, v2
    s_lshl_b32 s56, s52, 2
    s_add_u32 s56, s56, 0x20400
    v_add_u32 v4, s56, v6
    v_add_u32 v6, 0x20400, v6
    v_cndmask_b32 v112, v104, v105, vcc
    ds_write_b32 v4, v112 offset:16
    v_cndmask_b32 v113, v108, v109, vcc
    ds_write_b32 v4, v113 offset:32
    v_lshrrev_b32 v3, 5, v1
    s_lshl_b32 s56, s52, 7
    s_add_u32 s56, s56, 0x20a00
    v_lshl_add_u32 v4, v3, 4, s56
    s_lshl_b32 s56, s52, 8
    s_add_u32 s56, s56, 0x20c00
    v_lshl_add_u32 v5, v2, 3, s56
    v_cmp_gt_u32 vcc, 28, v2
    s_nop 1
    v_cndmask_b32 v114, 0, -1, vcc
    v_cmp_eq_u32 vcc, 28, v2
    s_nop 1
    v_cndmask_b32 v115, 0, v34, vcc
    v_mov_b32 v118, 0
    v_mov_b32 v119, 0
    v_cmp_eq_u32 vcc, 0, v3
    s_waitcnt lgkmcnt(0)
    s_barrier
    ds_read_b128 v[128:131], v6 offset:16
    ds_read_b128 v[132:135], v6 offset:32
    ds_read_b64 v[116:117], v5
    ds_read_b128 v[48:51], v4
    ds_read_b128 v[52:55], v4 offset:32
    ds_read_b128 v[56:59], v4 offset:64
    ds_read_b128 v[60:63], v4 offset:96
    s_waitcnt lgkmcnt(6)
    v_add_f32 v128, v128, v129
    v_add_f32 v130, v130, v131
    v_add_f32 v128, v128, v130
    v_cndmask_b32 v128, 0, v128, vcc
    v_cvt_pk_bf16_f32 v121, v128, 0
    v_lshlrev_b32 v130, 16, v121
    v_sub_f32 v130, v128, v130
    v_cvt_pk_bf16_f32 v120, v128, v130
    v_mov_b32 v122, 0
    v_mov_b32 v123, 0
    s_waitcnt lgkmcnt(5)
    v_add_f32 v132, v132, v133
    v_add_f32 v134, v134, v135
    v_add_f32 v132, v132, v134
    v_cndmask_b32 v132, 0, v132, vcc
    v_cvt_pk_bf16_f32 v125, v132, 0
    v_lshlrev_b32 v134, 16, v125
    v_sub_f32 v134, v132, v134
    v_cvt_pk_bf16_f32 v124, v132, v134
    v_mov_b32 v126, 0
    v_mov_b32 v127, 0
    s_waitcnt lgkmcnt(4)
    v_mfma_f32_32x32x16_bf16 v[72:87], v[116:119], v[120:123], v[72:87]
    v_mfma_f32_32x32x16_bf16 v[88:103], v[116:119], v[124:127], v[88:103]
    s_waitcnt lgkmcnt(3)
    s_nop 9
    v_pk_fma_f32 v[72:73], v[72:73], v[48:49], s[74:75]
    v_pk_fma_f32 v[74:75], v[74:75], v[50:51], s[74:75]
    s_waitcnt lgkmcnt(2)
    v_pk_fma_f32 v[76:77], v[76:77], v[52:53], s[74:75]
    v_pk_fma_f32 v[78:79], v[78:79], v[54:55], s[74:75]
    s_waitcnt lgkmcnt(1)
    v_pk_fma_f32 v[80:81], v[80:81], v[56:57], s[74:75]
    v_pk_fma_f32 v[82:83], v[82:83], v[58:59], s[74:75]
    s_waitcnt lgkmcnt(0)
    v_pk_fma_f32 v[84:85], v[84:85], v[60:61], s[74:75]
    v_pk_fma_f32 v[86:87], v[86:87], v[62:63], s[74:75]
    v_pk_mul_f32 v[136:137], v[72:73], s[76:77]
    v_pk_mul_f32 v[138:139], v[74:75], s[76:77]
    v_pk_mul_f32 v[140:141], v[76:77], s[76:77]
    v_pk_mul_f32 v[142:143], v[78:79], s[76:77]
    v_pk_mul_f32 v[144:145], v[80:81], s[76:77]
    v_pk_mul_f32 v[146:147], v[82:83], s[76:77]
    v_pk_mul_f32 v[148:149], v[84:85], s[76:77]
    v_pk_mul_f32 v[150:151], v[86:87], s[76:77]
    v_exp_f32 v136, v136 clamp
    v_max_f32 v72, s74, v72
    v_exp_f32 v137, v137 clamp
    v_max_f32 v73, s74, v73
    v_exp_f32 v138, v138 clamp
    v_max_f32 v74, s74, v74
    v_exp_f32 v139, v139 clamp
    v_max_f32 v75, s74, v75
    v_exp_f32 v140, v140 clamp
    v_max_f32 v76, s74, v76
    v_exp_f32 v141, v141 clamp
    v_max_f32 v77, s74, v77
    v_exp_f32 v142, v142 clamp
    v_max_f32 v78, s74, v78
    v_exp_f32 v143, v143 clamp
    v_max_f32 v79, s74, v79
    v_exp_f32 v144, v144 clamp
    v_max_f32 v80, s74, v80
    v_exp_f32 v145, v145 clamp
    v_max_f32 v81, s74, v81
    v_exp_f32 v146, v146 clamp
    v_max_f32 v82, s74, v82
    v_exp_f32 v147, v147 clamp
    v_max_f32 v83, s74, v83
    v_exp_f32 v148, v148 clamp
    v_max_f32 v84, s74, v84
    v_exp_f32 v149, v149 clamp
    v_max_f32 v85, s74, v85
    v_exp_f32 v150, v150 clamp
    v_max_f32 v86, s74, v86
    v_exp_f32 v151, v151 clamp
    v_max_f32 v87, s74, v87
    v_pk_add_f32 v[72:73], v[72:73], v[136:137]
    v_pk_add_f32 v[74:75], v[74:75], v[138:139]
    v_pk_add_f32 v[76:77], v[76:77], v[140:141]
    v_pk_add_f32 v[78:79], v[78:79], v[142:143]
    v_pk_add_f32 v[80:81], v[80:81], v[144:145]
    v_pk_add_f32 v[82:83], v[82:83], v[146:147]
    v_pk_add_f32 v[84:85], v[84:85], v[148:149]
    v_pk_add_f32 v[86:87], v[86:87], v[150:151]
    v_cvt_pk_bf16_f32 v152, v72, v73
    v_cvt_pk_bf16_f32 v153, v74, v75
    v_cvt_pk_bf16_f32 v154, v76, v77
    v_cvt_pk_bf16_f32 v155, v78, v79
    v_cvt_pk_bf16_f32 v156, v80, v81
    v_cvt_pk_bf16_f32 v157, v82, v83
    v_cvt_pk_bf16_f32 v158, v84, v85
    v_cvt_pk_bf16_f32 v159, v86, v87
    v_and_b32 v152, v114, v152
    v_and_b32 v153, v114, v153
    v_and_b32 v154, v114, v154
    v_and_b32 v155, v114, v155
    v_and_b32 v156, v114, v156
    v_and_b32 v157, v114, v157
    v_and_b32 v158, v114, v158
    v_and_b32 v159, v114, v159
    v_pk_mul_f32 v[88:89], v[88:89], v[48:49]
    v_pk_mul_f32 v[90:91], v[90:91], v[50:51]
    v_pk_mul_f32 v[92:93], v[92:93], v[52:53]
    v_pk_mul_f32 v[94:95], v[94:95], v[54:55]
    v_pk_mul_f32 v[96:97], v[96:97], v[56:57]
    v_pk_mul_f32 v[98:99], v[98:99], v[58:59]
    v_pk_mul_f32 v[100:101], v[100:101], v[60:61]
    v_pk_mul_f32 v[102:103], v[102:103], v[62:63]
    v_cvt_pk_bf16_f32 v160, v88, v89
    v_and_or_b32 v160, v160, v114, v115
    v_cvt_pk_bf16_f32 v161, v90, v91
    v_and_or_b32 v161, v161, v114, v115
    v_cvt_pk_bf16_f32 v162, v92, v93
    v_and_or_b32 v162, v162, v114, v115
    v_cvt_pk_bf16_f32 v163, v94, v95
    v_and_or_b32 v163, v163, v114, v115
    v_cvt_pk_bf16_f32 v164, v96, v97
    v_and_or_b32 v164, v164, v114, v115
    v_cvt_pk_bf16_f32 v165, v98, v99
    v_and_or_b32 v165, v165, v114, v115
    v_cvt_pk_bf16_f32 v166, v100, v101
    v_and_or_b32 v166, v166, v114, v115
    v_cvt_pk_bf16_f32 v167, v102, v103
    v_and_or_b32 v167, v167, v114, v115
    v_mfma_f32_32x32x16_bf16 v[72:87], v[152:155], v[160:163], 0
    s_nop 0
    v_mfma_f32_32x32x16_bf16 v[72:87], v[156:159], v[164:167], v[72:87]
    v_add_u32 v4, s83, v41
    s_lshl_b32 s56, s52, 10
    v_lshl_add_u32 v5, v1, 2, s56
    s_nop 8
    ds_write_b128 v4, v[72:75]
    ds_write_b128 v4, v[76:79] offset:1024
    ds_write_b128 v4, v[80:83] offset:2048
    ds_write_b128 v4, v[84:87] offset:3072
    s_waitcnt lgkmcnt(0)
    s_barrier
    ds_read2st64_b32 v[88:89], v5 offset0:0 offset1:1
    ds_read2st64_b32 v[90:91], v5 offset0:2 offset1:3
    ds_read2st64_b32 v[92:93], v5 offset0:16 offset1:17
    ds_read2st64_b32 v[94:95], v5 offset0:18 offset1:19
    ds_read2st64_b32 v[96:97], v5 offset0:32 offset1:33
    ds_read2st64_b32 v[98:99], v5 offset0:34 offset1:35
    ds_read2st64_b32 v[100:101], v5 offset0:48 offset1:49
    ds_read2st64_b32 v[102:103], v5 offset0:50 offset1:51
    s_waitcnt vmcnt(0)
    v_readfirstlane_b32 s57, v43
    s_nop 0
    s_cmp_lg_u32 s57, 0
    s_cbranch_scc1 K1_FLAG_OK
    s_mov_b32 s82, 0
    v_mov_b32 v3, 0
K1_POLL:
    buffer_load_dword v43, v3, s[40:43], s81 offen sc1
    s_waitcnt vmcnt(0)
    v_readfirstlane_b32 s57, v43
    s_add_u32 s82, s82, 1
    s_cmp_gt_u32 s82, 0x40000
    s_cbranch_scc1 K1_FLAG_OK
    s_cmp_eq_u32 s57, 0
    s_cbranch_scc1 K1_POLL
K1_FLAG_OK:
    s_waitcnt lgkmcnt(5)
    v_add_f32 v88, v88, v92
    s_waitcnt lgkmcnt(1)
    v_add_f32 v96, v96, v100
    v_add_f32 v88, v88, v96
    v_add_f32 v89, v89, v93
    v_add_f32 v97, v97, v101
    v_add_f32 v89, v89, v97
    v_add_f32 v90, v90, v94
    s_waitcnt lgkmcnt(0)
    v_add_f32 v98, v98, v102
    v_add_f32 v90, v90, v98
    v_add_f32 v91, v91, v95
    v_add_f32 v99, v99, v103
    v_add_f32 v91, v91, v99
    s_lshl_b32 s57, s54, 12
    s_add_u32 s57, s57, 0x0
    buffer_atomic_add_f32 v88, v5, s[36:39], s57 offen
    buffer_atomic_add_f32 v89, v5, s[36:39], s57 offen offset:256
    buffer_atomic_add_f32 v90, v5, s[36:39], s57 offen offset:512
    buffer_atomic_add_f32 v91, v5, s[36:39], s57 offen offset:768
K1_DONE:
    s_endpgm
K1_END:
.globl k2_kernel
.p2align 8
.type k2_kernel,@function
k2_kernel:
    s_cmp_ge_u32 s2, 224
    s_cbranch_scc1 K2_DONE
    s_load_dwordx2 s[24:25], s[0:1], 80
    s_load_dwordx4 s[16:19], s[0:1], 56
    v_and_b32 v1, 63, v0
    v_lshrrev_b32 v3, 6, v0
    s_nop 0
    v_readfirstlane_b32 s44, v3
    v_lshlrev_b32 v2, 4, v1
    v_lshrrev_b32 v9, 5, v1
    v_and_b32 v10, 31, v1
    s_and_b32 s49, s2, 7
    s_lshr_b32 s50, s2, 3
    s_cmp_ge_u32 s50, 14
    s_cselect_b32 s51, 1, 0
    s_lshl_b32 s45, s49, 1
    s_add_u32 s45, s45, s51
    s_mul_i32 s51, s51, 14
    s_sub_u32 s46, s50, s51
    s_cmp_ge_u32 s46, 7
    s_cselect_b32 s47, 1, 0
    s_mul_i32 s51, s47, 7
    s_sub_u32 s48, s46, s51
    s_lshr_b32 s53, s44, 1
    s_and_b32 s54, s44, 1
    s_movk_i32 s68, 4096
    s_movk_i32 s69, 8192
    s_movk_i32 s70, 12288
    s_lshl_b32 s49, s44, 14
    v_add_u32 v4, s49, v2
    s_lshl_b32 s50, s45, 1
    s_add_u32 s50, s50, s47
    s_lshl_b32 s51, s50, 16
    s_add_u32 s51, s51, s49
    s_add_u32 s51, s51, 0x3ee000
    v_add_u32 v5, s51, v2
    s_lshl_b32 s51, s48, 16
    s_add_u32 s51, s51, s49
    s_add_u32 s51, s51, 0x60000
    v_add_u32 v6, s51, v2
    s_waitcnt lgkmcnt(0)
    s_mov_b32 s32, s24
    s_and_b32 s33, s25, 0xffff
    s_mov_b32 s34, 0x10ee000
    s_mov_b32 s35, 0x00020000
    buffer_load_dwordx4 v[32:35], v4, s[32:35], 0 offen
    buffer_load_dwordx4 v[36:39], v4, s[32:35], 0 offen offset:1024
    buffer_load_dwordx4 v[40:43], v4, s[32:35], 0 offen offset:2048
    buffer_load_dwordx4 v[44:47], v4, s[32:35], 0 offen offset:3072
    buffer_load_dwordx4 v[96:99], v5, s[32:35], 0 offen
    buffer_load_dwordx4 v[100:103], v5, s[32:35], 0 offen offset:1024
    buffer_load_dwordx4 v[104:107], v5, s[32:35], 0 offen offset:2048
    buffer_load_dwordx4 v[108:111], v5, s[32:35], 0 offen offset:3072
    buffer_load_dwordx4 a[0:3], v6, s[32:35], 0 offen
    buffer_load_dwordx4 a[4:7], v6, s[32:35], 0 offen offset:1024
    buffer_load_dwordx4 a[8:11], v6, s[32:35], 0 offen offset:2048
    buffer_load_dwordx4 a[12:15], v6, s[32:35], 0 offen offset:3072
    buffer_load_dwordx4 v[48:51], v4, s[32:35], s68 offen
    buffer_load_dwordx4 v[52:55], v4, s[32:35], s68 offen offset:1024
    buffer_load_dwordx4 v[56:59], v4, s[32:35], s68 offen offset:2048
    buffer_load_dwordx4 v[60:63], v4, s[32:35], s68 offen offset:3072
    s_lshl_b32 s58, s50, 1
    s_add_u32 s58, s58, s53
    s_lshl_b32 s59, s48, 1
    s_add_u32 s59, s59, s54
    s_lshl_b32 s51, s50, 2
    s_add_u32 s51, s51, s44
    s_mul_i32 s51, s51, 57344
    s_add_u32 s61, s51, 0x7ae000
    s_lshl_b32 s51, s48, 2
    s_add_u32 s51, s51, s44
    s_mul_i32 s51, s51, 57344
    s_add_u32 s60, s51, 0x266000
    s_mov_b32 s36, s18
    s_and_b32 s37, s19, 0xffff
    s_mov_b32 s38, 0x1c0000
    s_mov_b32 s39, 0x00020000
    s_mov_b32 s40, s16
    s_and_b32 s41, s17, 0xffff
    s_mov_b32 s42, 0x380
    s_mov_b32 s43, 0x00020000
    s_mov_b32 s66, 1.0
    s_mov_b32 s67, 1.0
    s_lshl_b32 s49, s58, 5
    v_add_u32 v3, s49, v10
    s_movk_i32 s50, 896
    v_mul_lo_u32 v3, v3, s50
    v_lshl_add_u32 v8, v9, 3, v3
    s_lshl_b32 s72, s59, 6
    v_lshlrev_b32 v7, 3, v9
    s_mul_i32 s49, s58, 28
    s_lshl_b32 s50, s59, 1
    s_add_u32 s49, s49, s50
    s_lshl_b32 s49, s49, 10
    s_add_u32 s77, s49, 0xeae000
    s_add_u32 s78, s49, 0x5ee000
    v_lshlrev_b32 v3, 3, v9
    v_sub_u32 v3, v10, v3
    v_cmp_eq_u32 vcc, 0, v3
    v_mov_b32 v28, 0x3f80
    s_nop 0
    v_cndmask_b32 v29, 0, v28, vcc
    v_cmp_eq_u32 vcc, 1, v3
    v_mov_b32 v28, 0x3f800000
    s_nop 0
    v_cndmask_b32 v29, v29, v28, vcc
    v_accvgpr_write_b32 a240, v29
    v_cmp_eq_u32 vcc, 2, v3
    v_mov_b32 v28, 0x3f80
    s_nop 0
    v_cndmask_b32 v29, 0, v28, vcc
    v_cmp_eq_u32 vcc, 3, v3
    v_mov_b32 v28, 0x3f800000
    s_nop 0
    v_cndmask_b32 v29, v29, v28, vcc
    v_accvgpr_write_b32 a241, v29
    v_cmp_eq_u32 vcc, 4, v3
    v_mov_b32 v28, 0x3f80
    s_nop 0
    v_cndmask_b32 v29, 0, v28, vcc
    v_cmp_eq_u32 vcc, 5, v3
    v_mov_b32 v28, 0x3f800000
    s_nop 0
    v_cndmask_b32 v29, v29, v28, vcc
    v_accvgpr_write_b32 a242, v29
    v_cmp_eq_u32 vcc, 6, v3
    v_mov_b32 v28, 0x3f80
    s_nop 0
    v_cndmask_b32 v29, 0, v28, vcc
    v_cmp_eq_u32 vcc, 7, v3
    v_mov_b32 v28, 0x3f800000
    s_nop 0
    v_cndmask_b32 v29, v29, v28, vcc
    v_accvgpr_write_b32 a243, v29
    v_cmp_eq_u32 vcc, 16, v3
    v_mov_b32 v28, 0x3f80
    s_nop 0
    v_cndmask_b32 v29, 0, v28, vcc
    v_cmp_eq_u32 vcc, 17, v3
    v_mov_b32 v28, 0x3f800000
    s_nop 0
    v_cndmask_b32 v29, v29, v28, vcc
    v_accvgpr_write_b32 a244, v29
    v_cmp_eq_u32 vcc, 18, v3
    v_mov_b32 v28, 0x3f80
    s_nop 0
    v_cndmask_b32 v29, 0, v28, vcc
    v_cmp_eq_u32 vcc, 19, v3
    v_mov_b32 v28, 0x3f800000
    s_nop 0
    v_cndmask_b32 v29, v29, v28, vcc
    v_accvgpr_write_b32 a245, v29
    v_cmp_eq_u32 vcc, 20, v3
    v_mov_b32 v28, 0x3f80
    s_nop 0
    v_cndmask_b32 v29, 0, v28, vcc
    v_cmp_eq_u32 vcc, 21, v3
    v_mov_b32 v28, 0x3f800000
    s_nop 0
    v_cndmask_b32 v29, v29, v28, vcc
    v_accvgpr_write_b32 a246, v29
    v_cmp_eq_u32 vcc, 22, v3
    v_mov_b32 v28, 0x3f80
    s_nop 0
    v_cndmask_b32 v29, 0, v28, vcc
    v_cmp_eq_u32 vcc, 23, v3
    v_mov_b32 v28, 0x3f800000
    s_nop 0
    v_cndmask_b32 v29, v29, v28, vcc
    v_accvgpr_write_b32 a247, v29
    s_lshl_b32 s49, s46, 2
    s_add_u32 s49, s49, s44
    s_mul_i32 s49, s49, 29696
    s_add_u32 s64, s49, 0xd0000
    s_mul_i32 s65, s44, 28672
    s_lshl_b32 s62, s45, 11
    s_add_u32 s62, s62, 0x10000
    s_lshl_b32 s49, s46, 7
    s_add_u32 s56, s49, s62
    v_mov_b32 v11, 1
    v_mov_b32 v30, 0
    v_min_u32 v3, 6, v1
    s_mul_i32 s49, s53, 7
    v_add_u32 v3, s49, v3
    v_lshlrev_b32 v31, 7, v3
    v_add_u32 v28, 0xe000, v2
    s_waitcnt vmcnt(15)
    v_cvt_pk_bf16_f32 v32, v32, v33
    v_cvt_pk_bf16_f32 v33, v34, v35
    s_waitcnt vmcnt(14)
    v_cvt_pk_bf16_f32 v34, v36, v37
    v_cvt_pk_bf16_f32 v35, v38, v39
    s_waitcnt vmcnt(13)
    v_cvt_pk_bf16_f32 v36, v40, v41
    v_cvt_pk_bf16_f32 v37, v42, v43
    s_waitcnt vmcnt(12)
    v_cvt_pk_bf16_f32 v38, v44, v45
    v_cvt_pk_bf16_f32 v39, v46, v47
    s_waitcnt vmcnt(11)
    v_mfma_f32_32x32x16_bf16 v[224:239], v[32:35], v[96:99], 0
    buffer_load_dwordx4 v[112:115], v5, s[32:35], s68 offen
    buffer_load_dwordx4 v[116:119], v5, s[32:35], s68 offen offset:1024
    s_waitcnt vmcnt(12)
    v_mfma_f32_32x32x16_bf16 v[224:239], v[36:39], v[100:103], v[224:239]
    buffer_load_dwordx4 v[120:123], v5, s[32:35], s68 offen offset:2048
    buffer_load_dwordx4 v[124:127], v5, s[32:35], s68 offen offset:3072
    s_waitcnt vmcnt(13)
    v_mfma_f32_32x32x16_bf16 v[240:255], v[32:35], v[104:107], 0
    buffer_load_dwordx4 a[16:19], v6, s[32:35], s68 offen
    buffer_load_dwordx4 a[20:23], v6, s[32:35], s68 offen offset:1024
    s_waitcnt vmcnt(14)
    v_mfma_f32_32x32x16_bf16 v[240:255], v[36:39], v[108:111], v[240:255]
    buffer_load_dwordx4 a[24:27], v6, s[32:35], s68 offen offset:2048
    buffer_load_dwordx4 a[28:31], v6, s[32:35], s68 offen offset:3072
    s_nop 1
    v_add_f32 v3, 0x358637bd, v236
    v_rcp_f32 v3, v3
    s_nop 0
    v_mov_b32 v28, v3
    v_mov_b32 v29, v3
    s_nop 1
    v_permlane32_swap_b32 v28, v29
    v_mul_f32 v224, v29, v224
    v_mul_f32 v225, v29, v225
    v_mul_f32 v226, v29, v226
    v_mul_f32 v227, v29, v227
    v_mul_f32 v228, v29, v228
    v_mul_f32 v229, v29, v229
    v_mul_f32 v230, v29, v230
    v_mul_f32 v231, v29, v231
    v_mul_f32 v232, v29, v232
    v_mul_f32 v233, v29, v233
    v_mul_f32 v234, v29, v234
    v_mul_f32 v235, v29, v235
    v_mul_f32 v236, v29, v236
    v_mul_f32 v237, v29, v237
    v_mul_f32 v238, v29, v238
    v_mul_f32 v239, v29, v239
    v_cvt_pk_bf16_f32 v224, v224, v225
    v_cvt_pk_bf16_f32 v225, v226, v227
    v_cvt_pk_bf16_f32 v226, v228, v229
    v_cvt_pk_bf16_f32 v227, v230, v231
    v_cvt_pk_bf16_f32 v228, v232, v233
    v_cvt_pk_bf16_f32 v229, v234, v235
    v_cvt_pk_bf16_f32 v230, v236, v237
    v_cvt_pk_bf16_f32 v231, v238, v239
    s_waitcnt vmcnt(15)
    v_mfma_f32_32x32x16_bf16 v[160:175], a[0:3], v[224:227], 0
    buffer_load_dwordx4 v[64:67], v4, s[32:35], s69 offen
    buffer_load_dwordx4 v[68:71], v4, s[32:35], s69 offen offset:1024
    s_waitcnt vmcnt(16)
    v_mfma_f32_32x32x16_bf16 v[176:191], a[4:7], v[224:227], 0
    buffer_load_dwordx4 v[72:75], v4, s[32:35], s69 offen offset:2048
    buffer_load_dwordx4 v[76:79], v4, s[32:35], s69 offen offset:3072
    s_waitcnt vmcnt(17)
    v_mfma_f32_32x32x16_bf16 v[160:175], a[8:11], v[228:231], v[160:175]
    buffer_load_dwordx4 v[128:131], v5, s[32:35], s69 offen
    buffer_load_dwordx4 v[132:135], v5, s[32:35], s69 offen offset:1024
    s_waitcnt vmcnt(18)
    v_mfma_f32_32x32x16_bf16 v[176:191], a[12:15], v[228:231], v[176:191]
    buffer_load_dwordx4 v[136:139], v5, s[32:35], s69 offen offset:2048
    buffer_load_dwordx4 v[140:143], v5, s[32:35], s69 offen offset:3072
    s_waitcnt vmcnt(19)
    v_cvt_pk_bf16_f32 v48, v48, v49
    v_cvt_pk_bf16_f32 v49, v50, v51
    s_waitcnt vmcnt(18)
    v_cvt_pk_bf16_f32 v50, v52, v53
    v_cvt_pk_bf16_f32 v51, v54, v55
    s_waitcnt vmcnt(17)
    v_cvt_pk_bf16_f32 v52, v56, v57
    v_cvt_pk_bf16_f32 v53, v58, v59
    s_waitcnt vmcnt(16)
    v_cvt_pk_bf16_f32 v54, v60, v61
    v_cvt_pk_bf16_f32 v55, v62, v63
    s_waitcnt vmcnt(15)
    v_mfma_f32_32x32x16_bf16 v[224:239], v[48:51], v[112:115], 0
    buffer_load_dwordx4 a[32:35], v6, s[32:35], s69 offen
    buffer_load_dwordx4 a[36:39], v6, s[32:35], s69 offen offset:1024
    s_waitcnt vmcnt(16)
    v_mfma_f32_32x32x16_bf16 v[224:239], v[52:55], v[116:119], v[224:239]
    buffer_load_dwordx4 a[40:43], v6, s[32:35], s69 offen offset:2048
    buffer_load_dwordx4 a[44:47], v6, s[32:35], s69 offen offset:3072
    v_add_f32 v3, 0x358637bd, v252
    v_rcp_f32 v3, v3
    s_nop 0
    v_mov_b32 v28, v3
    v_mov_b32 v29, v3
    s_nop 1
    v_permlane32_swap_b32 v28, v29
    v_mul_f32 v240, v29, v240
    v_mul_f32 v241, v29, v241
    v_mul_f32 v242, v29, v242
    v_mul_f32 v243, v29, v243
    v_mul_f32 v244, v29, v244
    v_mul_f32 v245, v29, v245
    v_mul_f32 v246, v29, v246
    v_mul_f32 v247, v29, v247
    v_mul_f32 v248, v29, v248
    v_mul_f32 v249, v29, v249
    v_mul_f32 v250, v29, v250
    v_mul_f32 v251, v29, v251
    v_mul_f32 v252, v29, v252
    v_mul_f32 v253, v29, v253
    v_mul_f32 v254, v29, v254
    v_mul_f32 v255, v29, v255
    v_cvt_pk_bf16_f32 v240, v240, v241
    v_cvt_pk_bf16_f32 v241, v242, v243
    v_cvt_pk_bf16_f32 v242, v244, v245
    v_cvt_pk_bf16_f32 v243, v246, v247
    v_cvt_pk_bf16_f32 v244, v248, v249
    v_cvt_pk_bf16_f32 v245, v250, v251
    v_cvt_pk_bf16_f32 v246, v252, v253
    v_cvt_pk_bf16_f32 v247, v254, v255
    v_mfma_f32_32x32x16_bf16 v[192:207], a[0:3], v[240:243], 0
    buffer_load_dwordx4 v[80:83], v4, s[32:35], s70 offen
    buffer_load_dwordx4 v[84:87], v4, s[32:35], s70 offen offset:1024
    v_mfma_f32_32x32x16_bf16 v[208:223], a[4:7], v[240:243], 0
    buffer_load_dwordx4 v[88:91], v4, s[32:35], s70 offen offset:2048
    buffer_load_dwordx4 v[92:95], v4, s[32:35], s70 offen offset:3072
    v_mfma_f32_32x32x16_bf16 v[192:207], a[8:11], v[244:247], v[192:207]
    buffer_load_dwordx4 v[144:147], v5, s[32:35], s70 offen
    buffer_load_dwordx4 v[148:151], v5, s[32:35], s70 offen offset:1024
    v_mfma_f32_32x32x16_bf16 v[208:223], a[12:15], v[244:247], v[208:223]
    buffer_load_dwordx4 v[152:155], v5, s[32:35], s70 offen offset:2048
    buffer_load_dwordx4 v[156:159], v5, s[32:35], s70 offen offset:3072
    s_waitcnt vmcnt(25)
    v_mfma_f32_32x32x16_bf16 v[240:255], v[48:51], v[120:123], 0
    buffer_load_dwordx4 a[48:51], v6, s[32:35], s70 offen
    buffer_load_dwordx4 a[52:55], v6, s[32:35], s70 offen offset:1024
    s_waitcnt vmcnt(26)
    v_mfma_f32_32x32x16_bf16 v[240:255], v[52:55], v[124:127], v[240:255]
    buffer_load_dwordx4 a[56:59], v6, s[32:35], s70 offen offset:2048
    buffer_load_dwordx4 a[60:63], v6, s[32:35], s70 offen offset:3072
    v_add_f32 v3, 0x358637bd, v236
    v_rcp_f32 v3, v3
    s_nop 0
    v_mov_b32 v28, v3
    v_mov_b32 v29, v3
    s_nop 1
    v_permlane32_swap_b32 v28, v29
    v_mul_f32 v224, v29, v224
    v_mul_f32 v225, v29, v225
    v_mul_f32 v226, v29, v226
    v_mul_f32 v227, v29, v227
    v_mul_f32 v228, v29, v228
    v_mul_f32 v229, v29, v229
    v_mul_f32 v230, v29, v230
    v_mul_f32 v231, v29, v231
    v_mul_f32 v232, v29, v232
    v_mul_f32 v233, v29, v233
    v_mul_f32 v234, v29, v234
    v_mul_f32 v235, v29, v235
    v_mul_f32 v236, v29, v236
    v_mul_f32 v237, v29, v237
    v_mul_f32 v238, v29, v238
    v_mul_f32 v239, v29, v239
    v_cvt_pk_bf16_f32 v224, v224, v225
    v_cvt_pk_bf16_f32 v225, v226, v227
    v_cvt_pk_bf16_f32 v226, v228, v229
    v_cvt_pk_bf16_f32 v227, v230, v231
    v_cvt_pk_bf16_f32 v228, v232, v233
    v_cvt_pk_bf16_f32 v229, v234, v235
    v_cvt_pk_bf16_f32 v230, v236, v237
    v_cvt_pk_bf16_f32 v231, v238, v239
    s_waitcnt vmcnt(27)
    v_mfma_f32_32x32x16_bf16 v[160:175], a[16:19], v[224:227], v[160:175]
    buffer_load_dwordx4 v[12:15], v2, s[32:35], s77 offen
    buffer_load_dwordx4 v[16:19], v2, s[32:35], s77 offen offset:1024
    s_waitcnt vmcnt(28)
    v_mfma_f32_32x32x16_bf16 v[176:191], a[20:23], v[224:227], v[176:191]
    buffer_load_dwordx2 v[20:21], v7, s[40:43], s72 offen
    buffer_load_dwordx2 v[22:23], v7, s[40:43], s72 offen offset:16
    s_waitcnt vmcnt(29)
    v_mfma_f32_32x32x16_bf16 v[160:175], a[24:27], v[228:231], v[160:175]
    buffer_load_dwordx2 v[24:25], v7, s[40:43], s72 offen offset:32
    buffer_load_dwordx2 v[26:27], v7, s[40:43], s72 offen offset:48
    s_waitcnt vmcnt(30)
    v_mfma_f32_32x32x16_bf16 v[176:191], a[28:31], v[228:231], v[176:191]
    s_add_u32 m0, s65, 0x0
    s_nop 0
    buffer_load_dwordx4 v2, s[32:35], s64 offen lds
    s_waitcnt vmcnt(30)
    v_cvt_pk_bf16_f32 v64, v64, v65
    v_cvt_pk_bf16_f32 v65, v66, v67
    s_waitcnt vmcnt(29)
    v_cvt_pk_bf16_f32 v66, v68, v69
    v_cvt_pk_bf16_f32 v67, v70, v71
    s_waitcnt vmcnt(28)
    v_cvt_pk_bf16_f32 v68, v72, v73
    v_cvt_pk_bf16_f32 v69, v74, v75
    s_waitcnt vmcnt(27)
    v_cvt_pk_bf16_f32 v70, v76, v77
    v_cvt_pk_bf16_f32 v71, v78, v79
    s_waitcnt vmcnt(26)
    v_mfma_f32_32x32x16_bf16 v[224:239], v[64:67], v[128:131], 0
    s_waitcnt vmcnt(25)
    v_mfma_f32_32x32x16_bf16 v[224:239], v[68:71], v[132:135], v[224:239]
    buffer_load_dwordx4 v2, s[32:35], s64 offen offset:1024 lds
    v_add_f32 v3, 0x358637bd, v252
    v_rcp_f32 v3, v3
    s_nop 0
    v_mov_b32 v28, v3
    v_mov_b32 v29, v3
    s_nop 1
    v_permlane32_swap_b32 v28, v29
    v_mul_f32 v240, v29, v240
    v_mul_f32 v241, v29, v241
    v_mul_f32 v242, v29, v242
    v_mul_f32 v243, v29, v243
    v_mul_f32 v244, v29, v244
    v_mul_f32 v245, v29, v245
    v_mul_f32 v246, v29, v246
    v_mul_f32 v247, v29, v247
    v_mul_f32 v248, v29, v248
    v_mul_f32 v249, v29, v249
    v_mul_f32 v250, v29, v250
    v_mul_f32 v251, v29, v251
    v_mul_f32 v252, v29, v252
    v_mul_f32 v253, v29, v253
    v_mul_f32 v254, v29, v254
    v_mul_f32 v255, v29, v255
    v_cvt_pk_bf16_f32 v240, v240, v241
    v_cvt_pk_bf16_f32 v241, v242, v243
    v_cvt_pk_bf16_f32 v242, v244, v245
    v_cvt_pk_bf16_f32 v243, v246, v247
    v_cvt_pk_bf16_f32 v244, v248, v249
    v_cvt_pk_bf16_f32 v245, v250, v251
    v_cvt_pk_bf16_f32 v246, v252, v253
    v_cvt_pk_bf16_f32 v247, v254, v255
    v_mfma_f32_32x32x16_bf16 v[192:207], a[16:19], v[240:243], v[192:207]
    v_mfma_f32_32x32x16_bf16 v[208:223], a[20:23], v[240:243], v[208:223]
    buffer_load_dwordx4 v2, s[32:35], s64 offen offset:2048 lds
    v_mfma_f32_32x32x16_bf16 v[192:207], a[24:27], v[244:247], v[192:207]
    v_mfma_f32_32x32x16_bf16 v[208:223], a[28:31], v[244:247], v[208:223]
    buffer_load_dwordx4 v2, s[32:35], s64 offen offset:3072 lds
    s_add_u32 s64, s64, 4096
    s_waitcnt vmcnt(27)
    v_mfma_f32_32x32x16_bf16 v[240:255], v[64:67], v[136:139], 0
    s_waitcnt vmcnt(26)
    v_mfma_f32_32x32x16_bf16 v[240:255], v[68:71], v[140:143], v[240:255]
    s_add_u32 m0, s65, 0x1000
    s_nop 0
    buffer_load_dwordx4 v2, s[32:35], s64 offen lds
    v_add_f32 v3, 0x358637bd, v236
    v_rcp_f32 v3, v3
    s_nop 0
    v_mov_b32 v28, v3
    v_mov_b32 v29, v3
    s_nop 1
    v_permlane32_swap_b32 v28, v29
    v_mul_f32 v224, v29, v224
    v_mul_f32 v225, v29, v225
    v_mul_f32 v226, v29, v226
    v_mul_f32 v227, v29, v227
    v_mul_f32 v228, v29, v228
    v_mul_f32 v229, v29, v229
    v_mul_f32 v230, v29, v230
    v_mul_f32 v231, v29, v231
    v_mul_f32 v232, v29, v232
    v_mul_f32 v233, v29, v233
    v_mul_f32 v234, v29, v234
    v_mul_f32 v235, v29, v235
    v_mul_f32 v236, v29, v236
    v_mul_f32 v237, v29, v237
    v_mul_f32 v238, v29, v238
    v_mul_f32 v239, v29, v239
    v_cvt_pk_bf16_f32 v224, v224, v225
    v_cvt_pk_bf16_f32 v225, v226, v227
    v_cvt_pk_bf16_f32 v226, v228, v229
    v_cvt_pk_bf16_f32 v227, v230, v231
    v_cvt_pk_bf16_f32 v228, v232, v233
    v_cvt_pk_bf16_f32 v229, v234, v235
    v_cvt_pk_bf16_f32 v230, v236, v237
    v_cvt_pk_bf16_f32 v231, v238, v239
    s_waitcnt vmcnt(26)
    v_mfma_f32_32x32x16_bf16 v[160:175], a[32:35], v[224:227], v[160:175]
    s_waitcnt vmcnt(25)
    v_mfma_f32_32x32x16_bf16 v[176:191], a[36:39], v[224:227], v[176:191]
    buffer_load_dwordx4 v2, s[32:35], s64 offen offset:1024 lds
    s_waitcnt vmcnt(25)
    v_mfma_f32_32x32x16_bf16 v[160:175], a[40:43], v[228:231], v[160:175]
    s_waitcnt vmcnt(24)
    v_mfma_f32_32x32x16_bf16 v[176:191], a[44:47], v[228:231], v[176:191]
    buffer_load_dwordx4 v2, s[32:35], s64 offen offset:2048 lds
    s_waitcnt vmcnt(24)
    v_cvt_pk_bf16_f32 v80, v80, v81
    v_cvt_pk_bf16_f32 v81, v82, v83
    s_waitcnt vmcnt(23)
    v_cvt_pk_bf16_f32 v82, v84, v85
    v_cvt_pk_bf16_f32 v83, v86, v87
    s_waitcnt vmcnt(22)
    v_cvt_pk_bf16_f32 v84, v88, v89
    v_cvt_pk_bf16_f32 v85, v90, v91
    s_waitcnt vmcnt(21)
    v_cvt_pk_bf16_f32 v86, v92, v93
    v_cvt_pk_bf16_f32 v87, v94, v95
    s_waitcnt vmcnt(20)
    v_mfma_f32_32x32x16_bf16 v[224:239], v[80:83], v[144:147], 0
    s_waitcnt vmcnt(19)
    v_mfma_f32_32x32x16_bf16 v[224:239], v[84:87], v[148:151], v[224:239]
    buffer_load_dwordx4 v2, s[32:35], s64 offen offset:3072 lds
    s_add_u32 s64, s64, 4096
    v_add_f32 v3, 0x358637bd, v252
    v_rcp_f32 v3, v3
    s_nop 0
    v_mov_b32 v28, v3
    v_mov_b32 v29, v3
    s_nop 1
    v_permlane32_swap_b32 v28, v29
    v_mul_f32 v240, v29, v240
    v_mul_f32 v241, v29, v241
    v_mul_f32 v242, v29, v242
    v_mul_f32 v243, v29, v243
    v_mul_f32 v244, v29, v244
    v_mul_f32 v245, v29, v245
    v_mul_f32 v246, v29, v246
    v_mul_f32 v247, v29, v247
    v_mul_f32 v248, v29, v248
    v_mul_f32 v249, v29, v249
    v_mul_f32 v250, v29, v250
    v_mul_f32 v251, v29, v251
    v_mul_f32 v252, v29, v252
    v_mul_f32 v253, v29, v253
    v_mul_f32 v254, v29, v254
    v_mul_f32 v255, v29, v255
    v_cvt_pk_bf16_f32 v240, v240, v241
    v_cvt_pk_bf16_f32 v241, v242, v243
    v_cvt_pk_bf16_f32 v242, v244, v245
    v_cvt_pk_bf16_f32 v243, v246, v247
    v_cvt_pk_bf16_f32 v244, v248, v249
    v_cvt_pk_bf16_f32 v245, v250, v251
    v_cvt_pk_bf16_f32 v246, v252, v253
    v_cvt_pk_bf16_f32 v247, v254, v255
    v_mfma_f32_32x32x16_bf16 v[192:207], a[32:35], v[240:243], v[192:207]
    v_mfma_f32_32x32x16_bf16 v[208:223], a[36:39], v[240:243], v[208:223]
    s_add_u32 m0, s65, 0x2000
    s_nop 0
    buffer_load_dwordx4 v2, s[32:35], s64 offen lds
    v_mfma_f32_32x32x16_bf16 v[192:207], a[40:43], v[244:247], v[192:207]
    v_mfma_f32_32x32x16_bf16 v[208:223], a[44:47], v[244:247], v[208:223]
    buffer_load_dwordx4 v2, s[32:35], s64 offen offset:1024 lds
    s_waitcnt vmcnt(21)
    v_mfma_f32_32x32x16_bf16 v[240:255], v[80:83], v[152:155], 0
    s_waitcnt vmcnt(20)
    v_mfma_f32_32x32x16_bf16 v[240:255], v[84:87], v[156:159], v[240:255]
    buffer_load_dwordx4 v2, s[32:35], s64 offen offset:2048 lds
    v_add_f32 v3, 0x358637bd, v236
    v_rcp_f32 v3, v3
    s_nop 0
    v_mov_b32 v28, v3
    v_mov_b32 v29, v3
    s_nop 1
    v_permlane32_swap_b32 v28, v29
    v_mul_f32 v224, v29, v224
    v_mul_f32 v225, v29, v225
    v_mul_f32 v226, v29, v226
    v_mul_f32 v227, v29, v227
    v_mul_f32 v228, v29, v228
    v_mul_f32 v229, v29, v229
    v_mul_f32 v230, v29, v230
    v_mul_f32 v231, v29, v231
    v_mul_f32 v232, v29, v232
    v_mul_f32 v233, v29, v233
    v_mul_f32 v234, v29, v234
    v_mul_f32 v235, v29, v235
    v_mul_f32 v236, v29, v236
    v_mul_f32 v237, v29, v237
    v_mul_f32 v238, v29, v238
    v_mul_f32 v239, v29, v239
    v_cvt_pk_bf16_f32 v224, v224, v225
    v_cvt_pk_bf16_f32 v225, v226, v227
    v_cvt_pk_bf16_f32 v226, v228, v229
    v_cvt_pk_bf16_f32 v227, v230, v231
    v_cvt_pk_bf16_f32 v228, v232, v233
    v_cvt_pk_bf16_f32 v229, v234, v235
    v_cvt_pk_bf16_f32 v230, v236, v237
    v_cvt_pk_bf16_f32 v231, v238, v239
    s_waitcnt vmcnt(20)
    v_mfma_f32_32x32x16_bf16 v[160:175], a[48:51], v[224:227], v[160:175]
    s_waitcnt vmcnt(19)
    v_mfma_f32_32x32x16_bf16 v[176:191], a[52:55], v[224:227], v[176:191]
    buffer_load_dwordx4 v2, s[32:35], s64 offen offset:3072 lds
    s_add_u32 s64, s64, 4096
    s_waitcnt vmcnt(19)
    v_mfma_f32_32x32x16_bf16 v[160:175], a[56:59], v[228:231], v[160:175]
    s_waitcnt vmcnt(18)
    v_mfma_f32_32x32x16_bf16 v[176:191], a[60:63], v[228:231], v[176:191]
    v_add_f32 v3, 0x358637bd, v252
    v_rcp_f32 v3, v3
    s_nop 0
    v_mov_b32 v28, v3
    v_mov_b32 v29, v3
    s_nop 1
    v_permlane32_swap_b32 v28, v29
    v_mul_f32 v240, v29, v240
    v_mul_f32 v241, v29, v241
    v_mul_f32 v242, v29, v242
    v_mul_f32 v243, v29, v243
    v_mul_f32 v244, v29, v244
    v_mul_f32 v245, v29, v245
    v_mul_f32 v246, v29, v246
    v_mul_f32 v247, v29, v247
    v_mul_f32 v248, v29, v248
    v_mul_f32 v249, v29, v249
    v_mul_f32 v250, v29, v250
    v_mul_f32 v251, v29, v251
    v_mul_f32 v252, v29, v252
    v_mul_f32 v253, v29, v253
    v_mul_f32 v254, v29, v254
    v_mul_f32 v255, v29, v255
    v_cvt_pk_bf16_f32 v240, v240, v241
    v_cvt_pk_bf16_f32 v241, v242, v243
    v_cvt_pk_bf16_f32 v242, v244, v245
    v_cvt_pk_bf16_f32 v243, v246, v247
    v_cvt_pk_bf16_f32 v244, v248, v249
    v_cvt_pk_bf16_f32 v245, v250, v251
    v_cvt_pk_bf16_f32 v246, v252, v253
    v_cvt_pk_bf16_f32 v247, v254, v255
    v_mfma_f32_32x32x16_bf16 v[192:207], a[48:51], v[240:243], v[192:207]
    v_mfma_f32_32x32x16_bf16 v[208:223], a[52:55], v[240:243], v[208:223]
    v_mfma_f32_32x32x16_bf16 v[192:207], a[56:59], v[244:247], v[192:207]
    v_mfma_f32_32x32x16_bf16 v[208:223], a[60:63], v[244:247], v[208:223]
    s_waitcnt vmcnt(17)
    v_mfma_f32_32x32x16_bf16 v[160:175], a[240:243], v[12:15], v[160:175]
    s_waitcnt vmcnt(16)
    v_mfma_f32_32x32x16_bf16 v[160:175], a[244:247], v[16:19], v[160:175]
    v_add_u32 v28, 0xe000, v2
    s_xor_b32 s49, s44, 1
    s_mul_i32 s49, s49, 12288
    s_add_u32 s49, s49, 0x1c000
    v_add_u32 v3, s49, v2
    ds_write_b128 v3, v[176:179]
    ds_write_b128 v3, v[180:183] offset:1024
    ds_write_b128 v3, v[184:187] offset:2048
    ds_write_b128 v3, v[188:191] offset:3072
    s_xor_b32 s49, s44, 2
    s_mul_i32 s49, s49, 12288
    s_add_u32 s49, s49, 0x1d000
    v_add_u32 v3, s49, v2
    ds_write_b128 v3, v[192:195]
    ds_write_b128 v3, v[196:199] offset:1024
    ds_write_b128 v3, v[200:203] offset:2048
    ds_write_b128 v3, v[204:207] offset:3072
    s_xor_b32 s49, s44, 3
    s_mul_i32 s49, s49, 12288
    s_add_u32 s49, s49, 0x1e000
    v_add_u32 v3, s49, v2
    ds_write_b128 v3, v[208:211]
    ds_write_b128 v3, v[212:215] offset:1024
    ds_write_b128 v3, v[216:219] offset:2048
    ds_write_b128 v3, v[220:223] offset:3072
    s_mul_i32 s49, s44, 12288
    s_add_u32 s49, s49, 0x1c000
    v_add_u32 v3, s49, v2
    s_add_u32 m0, s65, 0x3000
    s_nop 0
    buffer_load_dwordx4 v2, s[32:35], s64 offen lds
    buffer_load_dwordx4 v2, s[32:35], s64 offen offset:1024 lds
    buffer_load_dwordx4 v2, s[32:35], s64 offen offset:2048 lds
    buffer_load_dwordx4 v2, s[32:35], s64 offen offset:3072 lds
    s_add_u32 s64, s64, 4096
    s_add_u32 m0, s65, 0x4000
    s_nop 0
    buffer_load_dwordx4 v2, s[32:35], s64 offen lds
    buffer_load_dwordx4 v2, s[32:35], s64 offen offset:1024 lds
    s_waitcnt lgkmcnt(0)
    s_barrier
    ds_read_b128 v[32:35], v3
    ds_read_b128 v[36:39], v3 offset:1024
    ds_read_b128 v[40:43], v3 offset:2048
    ds_read_b128 v[44:47], v3 offset:3072
    ds_read_b128 v[48:51], v3 offset:4096
    ds_read_b128 v[52:55], v3 offset:5120
    ds_read_b128 v[56:59], v3 offset:6144
    ds_read_b128 v[60:63], v3 offset:7168
    ds_read_b128 v[64:67], v3 offset:8192
    ds_read_b128 v[68:71], v3 offset:9216
    ds_read_b128 v[72:75], v3 offset:10240
    ds_read_b128 v[76:79], v3 offset:11264
    s_waitcnt lgkmcnt(11)
    v_pk_add_f32 v[160:161], v[160:161], v[32:33]
    v_pk_add_f32 v[162:163], v[162:163], v[34:35]
    s_waitcnt lgkmcnt(10)
    v_pk_add_f32 v[164:165], v[164:165], v[36:37]
    v_pk_add_f32 v[166:167], v[166:167], v[38:39]
    s_waitcnt lgkmcnt(9)
    v_pk_add_f32 v[168:169], v[168:169], v[40:41]
    v_pk_add_f32 v[170:171], v[170:171], v[42:43]
    s_waitcnt lgkmcnt(8)
    v_pk_add_f32 v[172:173], v[172:173], v[44:45]
    v_pk_add_f32 v[174:175], v[174:175], v[46:47]
    s_waitcnt lgkmcnt(7)
    v_pk_add_f32 v[160:161], v[160:161], v[48:49]
    v_pk_add_f32 v[162:163], v[162:163], v[50:51]
    s_waitcnt lgkmcnt(6)
    v_pk_add_f32 v[164:165], v[164:165], v[52:53]
    v_pk_add_f32 v[166:167], v[166:167], v[54:55]
    s_waitcnt lgkmcnt(5)
    v_pk_add_f32 v[168:169], v[168:169], v[56:57]
    v_pk_add_f32 v[170:171], v[170:171], v[58:59]
    s_waitcnt lgkmcnt(4)
    v_pk_add_f32 v[172:173], v[172:173], v[60:61]
    v_pk_add_f32 v[174:175], v[174:175], v[62:63]
    s_waitcnt lgkmcnt(3)
    v_pk_add_f32 v[160:161], v[160:161], v[64:65]
    v_pk_add_f32 v[162:163], v[162:163], v[66:67]
    s_waitcnt lgkmcnt(2)
    v_pk_add_f32 v[164:165], v[164:165], v[68:69]
    v_pk_add_f32 v[166:167], v[166:167], v[70:71]
    s_waitcnt lgkmcnt(1)
    v_pk_add_f32 v[168:169], v[168:169], v[72:73]
    v_pk_add_f32 v[170:171], v[170:171], v[74:75]
    s_waitcnt lgkmcnt(0)
    v_pk_add_f32 v[172:173], v[172:173], v[76:77]
    v_pk_add_f32 v[174:175], v[174:175], v[78:79]
    v_cvt_pk_bf16_f32 v12, v160, v161
    v_cvt_pk_bf16_f32 v13, v162, v163
    v_cvt_pk_bf16_f32 v14, v164, v165
    v_cvt_pk_bf16_f32 v15, v166, v167
    v_cvt_pk_bf16_f32 v16, v168, v169
    v_cvt_pk_bf16_f32 v17, v170, v171
    v_cvt_pk_bf16_f32 v18, v172, v173
    v_cvt_pk_bf16_f32 v19, v174, v175
    buffer_store_dwordx4 v[12:15], v2, s[32:35], s78 offen sc1
    buffer_store_dwordx4 v[16:19], v2, s[32:35], s78 offen offset:1024 sc1
    v_mov_b32 v5, 0x3f803f80
    v_dot2_f32_bf16 v3, v12, v5, 0
    v_dot2_f32_bf16 v4, v12, v12, 0
    v_dot2_f32_bf16 v3, v13, v5, v3
    v_dot2_f32_bf16 v4, v13, v13, v4
    v_dot2_f32_bf16 v3, v14, v5, v3
    v_dot2_f32_bf16 v4, v14, v14, v4
    v_dot2_f32_bf16 v3, v15, v5, v3
    v_dot2_f32_bf16 v4, v15, v15, v4
    v_dot2_f32_bf16 v3, v16, v5, v3
    v_dot2_f32_bf16 v4, v16, v16, v4
    v_dot2_f32_bf16 v3, v17, v5, v3
    v_dot2_f32_bf16 v4, v17, v17, v4
    v_dot2_f32_bf16 v3, v18, v5, v3
    v_dot2_f32_bf16 v4, v18, v18, v4
    v_dot2_f32_bf16 v3, v19, v5, v3
    v_dot2_f32_bf16 v4, v19, v19, v4
    s_nop 1
    v_mov_b32 v6, v3
    v_mov_b32 v224, v3
    s_nop 1
    v_permlane32_swap_b32 v6, v224
    v_add_f32 v224, v224, v6
    v_mov_b32 v6, v4
    v_mov_b32 v225, v4
    s_nop 1
    v_permlane32_swap_b32 v6, v225
    v_add_f32 v225, v225, v6
    v_cmp_eq_u32 vcc, 0, v9
    v_lshlrev_b32 v3, 3, v10
    v_mov_b32 v4, 0x7f000000
    v_cndmask_b32 v3, v4, v3, vcc
    s_mul_i32 s49, s58, 14
    s_add_u32 s49, s49, s59
    s_lshl_b32 s49, s49, 8
    s_add_u32 s49, s49, 0x28000
    buffer_store_dwordx2 v[224:225], v3, s[32:35], s49 offen sc1
    s_lshl_b32 s73, s45, 2
    s_add_u32 s73, s73, s44
    s_mul_i32 s74, s73, 28672
    s_add_u32 s74, s74, 0x5ee000
    s_mul_i32 s51, s73, 3584
    s_add_u32 s51, s51, 0x28000
    v_mul_u32_u24 v7, 1792, v9
    v_lshl_add_u32 v7, v10, 3, v7
    v_add_u32 v7, s51, v7
    s_lshr_b32 s49, s73, 1
    s_mul_i32 s49, s49, 224
    s_lshl_b32 s50, s46, 1
    s_add_u32 s49, s49, s50
    s_add_u32 s50, s49, s54
    s_lshl_b32 s50, s50, 10
    s_add_u32 s75, s50, 0x7ae000
    s_xor_b32 s50, s54, 1
    s_add_u32 s50, s49, s50
    s_lshl_b32 s50, s50, 10
    s_add_u32 s76, s50, 0x7ae000
    v_bfe_u32 v3, v1, 3, 2
    v_mul_u32_u24 v3, 57344, v3
    v_and_b32 v4, 7, v1
    v_lshl_add_u32 v3, v4, 7, v3
    v_bfe_u32 v4, v1, 4, 1
    v_cmp_eq_u32 vcc, 1, v4
    v_mov_b32 v4, s75
    v_mov_b32 v5, s76
    v_cndmask_b32 v4, v4, v5, vcc
    v_add_u32 v29, v3, v4
    s_movk_i32 s80, 28672
    s_waitcnt vmcnt(0)
    s_barrier
    s_add_u32 s49, s56, 0
    s_cmp_eq_u32 s44, 0
    s_cselect_b32 s49, s49, 0x7f000000
    buffer_store_dword v11, v30, s[32:35], s49 offen sc1
    v_mov_b32 v3, 0x1c400
    ds_write_b32 v3, v30 offset:4
    ds_write_b32 v3, v30 offset:8
    buffer_load_dwordx4 v2, s[32:35], s64 offen offset:2048 lds
    buffer_load_dwordx4 v2, s[32:35], s64 offen offset:3072 lds
    s_add_u32 s64, s64, 4096
    s_add_u32 m0, s65, 0x5000
    s_nop 0
    buffer_load_dwordx4 v2, s[32:35], s64 offen lds
    buffer_load_dwordx4 v2, s[32:35], s64 offen offset:1024 lds
    buffer_load_dwordx4 v2, s[32:35], s64 offen offset:2048 lds
    buffer_load_dwordx4 v2, s[32:35], s64 offen offset:3072 lds
    s_add_u32 s64, s64, 4096
    s_add_u32 m0, s65, 0x6000
    s_nop 0
    buffer_load_dwordx4 v2, s[32:35], s64 offen lds
    buffer_load_dwordx4 v2, s[32:35], s64 offen offset:1024 lds
    buffer_load_dwordx4 v2, s[32:35], s64 offen offset:2048 lds
    buffer_load_dwordx4 v2, s[32:35], s64 offen offset:3072 lds
    s_add_u32 s64, s64, 4096
    s_mul_i32 s52, s46, 118784
    s_add_u32 s52, s52, 0xd7000
    buffer_load_dwordx4 a[224:227], v2, s[32:35], s52 offen
    s_mul_i32 s52, s46, 118784
    s_add_u32 s52, s52, 0xde400
    buffer_load_dwordx4 a[228:231], v2, s[32:35], s52 offen
    s_mul_i32 s52, s46, 118784
    s_add_u32 s52, s52, 0xe5800
    buffer_load_dwordx4 a[232:235], v2, s[32:35], s52 offen
    s_mul_i32 s52, s46, 118784
    s_add_u32 s52, s52, 0xecc00
    buffer_load_dwordx4 a[236:239], v2, s[32:35], s52 offen
    buffer_load_dwordx4 a[0:3], v2, s[32:35], s60 offen
    buffer_load_dwordx4 a[4:7], v2, s[32:35], s60 offen offset:1024
    buffer_load_dwordx4 a[8:11], v2, s[32:35], s60 offen offset:2048
    buffer_load_dwordx4 a[12:15], v2, s[32:35], s60 offen offset:3072
    s_add_u32 s60, s60, 4096
    buffer_load_dwordx4 a[16:19], v2, s[32:35], s60 offen
    buffer_load_dwordx4 a[20:23], v2, s[32:35], s60 offen offset:1024
    buffer_load_dwordx4 a[24:27], v2, s[32:35], s60 offen offset:2048
    buffer_load_dwordx4 a[28:31], v2, s[32:35], s60 offen offset:3072
    s_add_u32 s60, s60, 4096
    s_add_u32 s63, s62, 0
    buffer_load_dword v255, v31, s[32:35], s63 offen sc1
    s_waitcnt vmcnt(0)
    v_cmp_ne_u32 vcc, 1, v255
    s_mov_b32 s55, 0
    s_nop 1
    s_cbranch_vccz K2_OKA
K2_POLLA:
    buffer_load_dword v255, v31, s[32:35], s63 offen sc1
    s_waitcnt vmcnt(0)
    v_cmp_ne_u32 vcc, 1, v255
    s_add_u32 s55, s55, 1
    s_cmp_gt_u32 s55, 0x40000
    s_cbranch_scc1 K2_OKA
    s_nop 1
    s_cbranch_vccnz K2_POLLA
K2_OKA:
    buffer_load_dwordx4 v[32:35], v2, s[32:35], s74 offen sc1
    buffer_load_dwordx4 v[36:39], v2, s[32:35], s74 offen offset:1024 sc1
    buffer_load_dwordx4 v[40:43], v2, s[32:35], s74 offen offset:2048 sc1
    buffer_load_dwordx4 v[44:47], v2, s[32:35], s74 offen offset:3072 sc1
    s_add_u32 s74, s74, 4096
    buffer_load_dwordx4 v[48:51], v2, s[32:35], s74 offen sc1
    buffer_load_dwordx4 v[52:55], v2, s[32:35], s74 offen offset:1024 sc1
    buffer_load_dwordx4 v[56:59], v2, s[32:35], s74 offen offset:2048 sc1
    buffer_load_dwordx4 v[60:63], v2, s[32:35], s74 offen offset:3072 sc1
    s_add_u32 s74, s74, 4096
    buffer_load_dwordx4 v[64:67], v2, s[32:35], s74 offen sc1
    buffer_load_dwordx4 v[68:71], v2, s[32:35], s74 offen offset:1024 sc1
    buffer_load_dwordx4 v[72:75], v2, s[32:35], s74 offen offset:2048 sc1
    buffer_load_dwordx4 v[76:79], v2, s[32:35], s74 offen offset:3072 sc1
    s_add_u32 s74, s74, 4096
    buffer_load_dwordx4 v[80:83], v2, s[32:35], s74 offen sc1
    buffer_load_dwordx4 v[84:87], v2, s[32:35], s74 offen offset:1024 sc1
    s_waitcnt lgkmcnt(0)
    s_barrier
    ds_read_b128 v[144:147], v2
    ds_read_b128 v[148:151], v2 offset:28672
    ds_read_b128 v[152:155], v28
    ds_read_b128 v[156:159], v2 offset:1024
    s_waitcnt vmcnt(13) lgkmcnt(3)
    v_mfma_f32_32x32x16_bf16 v[160:175], v[144:147], v[32:35], 0
    buffer_load_dwordx4 v[88:91], v2, s[32:35], s74 offen offset:2048 sc1
    ds_read_b128 v[144:147], v2 offset:29696
    s_waitcnt lgkmcnt(3)
    v_mfma_f32_32x32x16_bf16 v[176:191], v[148:151], v[32:35], 0
    ds_read_b128 v[148:151], v28 offset:1024
    s_waitcnt lgkmcnt(3)
    v_mfma_f32_32x32x16_bf16 v[192:207], v[152:155], v[32:35], 0
    ds_read_b128 v[152:155], v2 offset:2048
    s_waitcnt vmcnt(13) lgkmcnt(3)
    v_mfma_f32_32x32x16_bf16 v[160:175], v[156:159], v[36:39], v[160:175]
    buffer_load_dwordx4 v[92:95], v2, s[32:35], s74 offen offset:3072 sc1
    s_add_u32 s74, s74, 4096
    ds_read_b128 v[156:159], v2 offset:30720
    s_waitcnt lgkmcnt(3)
    v_mfma_f32_32x32x16_bf16 v[176:191], v[144:147], v[36:39], v[176:191]
    ds_read_b128 v[144:147], v28 offset:2048
    s_waitcnt lgkmcnt(3)
    v_mfma_f32_32x32x16_bf16 v[192:207], v[148:151], v[36:39], v[192:207]
    ds_read_b128 v[148:151], v2 offset:3072
    s_waitcnt vmcnt(13) lgkmcnt(3)
    v_mfma_f32_32x32x16_bf16 v[160:175], v[152:155], v[40:43], v[160:175]
    buffer_load_dwordx4 v[96:99], v2, s[32:35], s74 offen sc1
    ds_read_b128 v[152:155], v2 offset:31744
    s_waitcnt lgkmcnt(3)
    v_mfma_f32_32x32x16_bf16 v[176:191], v[156:159], v[40:43], v[176:191]
    ds_read_b128 v[156:159], v28 offset:3072
    s_waitcnt lgkmcnt(3)
    v_mfma_f32_32x32x16_bf16 v[192:207], v[144:147], v[40:43], v[192:207]
    ds_read_b128 v[144:147], v2 offset:4096
    s_waitcnt vmcnt(13) lgkmcnt(3)
    v_mfma_f32_32x32x16_bf16 v[160:175], v[148:151], v[44:47], v[160:175]
    buffer_load_dwordx4 v[100:103], v2, s[32:35], s74 offen offset:1024 sc1
    ds_read_b128 v[148:151], v2 offset:32768
    s_waitcnt lgkmcnt(3)
    v_mfma_f32_32x32x16_bf16 v[176:191], v[152:155], v[44:47], v[176:191]
    ds_read_b128 v[152:155], v28 offset:4096
    s_waitcnt lgkmcnt(3)
    v_mfma_f32_32x32x16_bf16 v[192:207], v[156:159], v[44:47], v[192:207]
    ds_read_b128 v[156:159], v2 offset:5120
    s_waitcnt vmcnt(13) lgkmcnt(3)
    v_mfma_f32_32x32x16_bf16 v[160:175], v[144:147], v[48:51], v[160:175]
    buffer_load_dwordx4 v[104:107], v2, s[32:35], s74 offen offset:2048 sc1
    ds_read_b128 v[144:147], v2 offset:33792
    s_waitcnt lgkmcnt(3)
    v_mfma_f32_32x32x16_bf16 v[176:191], v[148:151], v[48:51], v[176:191]
    ds_read_b128 v[148:151], v28 offset:5120
    s_waitcnt lgkmcnt(3)
    v_mfma_f32_32x32x16_bf16 v[192:207], v[152:155], v[48:51], v[192:207]
    ds_read_b128 v[152:155], v2 offset:6144
    s_waitcnt vmcnt(13) lgkmcnt(3)
    v_mfma_f32_32x32x16_bf16 v[160:175], v[156:159], v[52:55], v[160:175]
    buffer_load_dwordx4 v[108:111], v2, s[32:35], s74 offen offset:3072 sc1
    s_add_u32 s74, s74, 4096
    ds_read_b128 v[156:159], v2 offset:34816
    s_waitcnt lgkmcnt(3)
    v_mfma_f32_32x32x16_bf16 v[176:191], v[144:147], v[52:55], v[176:191]
    ds_read_b128 v[144:147], v28 offset:6144
    s_waitcnt lgkmcnt(3)
    v_mfma_f32_32x32x16_bf16 v[192:207], v[148:151], v[52:55], v[192:207]
    ds_read_b128 v[148:151], v2 offset:7168
    s_waitcnt vmcnt(13) lgkmcnt(3)
    v_mfma_f32_32x32x16_bf16 v[160:175], v[152:155], v[56:59], v[160:175]
    buffer_load_dwordx4 v[112:115], v2, s[32:35], s74 offen sc1
    ds_read_b128 v[152:155], v2 offset:35840
    s_waitcnt lgkmcnt(3)
    v_mfma_f32_32x32x16_bf16 v[176:191], v[156:159], v[56:59], v[176:191]
    ds_read_b128 v[156:159], v28 offset:7168
    s_waitcnt lgkmcnt(3)
    v_mfma_f32_32x32x16_bf16 v[192:207], v[144:147], v[56:59], v[192:207]
    ds_read_b128 v[144:147], v2 offset:8192
    s_waitcnt vmcnt(13) lgkmcnt(3)
    v_mfma_f32_32x32x16_bf16 v[160:175], v[148:151], v[60:63], v[160:175]
    buffer_load_dwordx4 v[116:119], v2, s[32:35], s74 offen offset:1024 sc1
    ds_read_b128 v[148:151], v2 offset:36864
    s_waitcnt lgkmcnt(3)
    v_mfma_f32_32x32x16_bf16 v[176:191], v[152:155], v[60:63], v[176:191]
    buffer_load_dwordx4 a[32:35], v2, s[32:35], s60 offen
    ds_read_b128 v[152:155], v28 offset:8192
    s_waitcnt lgkmcnt(3)
    v_mfma_f32_32x32x16_bf16 v[192:207], v[156:159], v[60:63], v[192:207]
    ds_read_b128 v[156:159], v2 offset:9216
    s_waitcnt vmcnt(14) lgkmcnt(3)
    v_mfma_f32_32x32x16_bf16 v[160:175], v[144:147], v[64:67], v[160:175]
    buffer_load_dwordx4 v[120:123], v2, s[32:35], s74 offen offset:2048 sc1
    buffer_load_dwordx4 a[36:39], v2, s[32:35], s60 offen offset:1024
    ds_read_b128 v[144:147], v2 offset:37888
    s_waitcnt lgkmcnt(3)
    v_mfma_f32_32x32x16_bf16 v[176:191], v[148:151], v[64:67], v[176:191]
    ds_read_b128 v[148:151], v28 offset:9216
    s_waitcnt lgkmcnt(3)
    v_mfma_f32_32x32x16_bf16 v[192:207], v[152:155], v[64:67], v[192:207]
    buffer_load_dwordx4 a[40:43], v2, s[32:35], s60 offen offset:2048
    ds_read_b128 v[152:155], v2 offset:10240
    s_waitcnt vmcnt(16) lgkmcnt(3)
    v_mfma_f32_32x32x16_bf16 v[160:175], v[156:159], v[68:71], v[160:175]
    buffer_load_dwordx4 v[124:127], v2, s[32:35], s74 offen offset:3072 sc1
    s_add_u32 s74, s74, 4096
    ds_read_b128 v[156:159], v2 offset:38912
    s_waitcnt lgkmcnt(3)
    v_mfma_f32_32x32x16_bf16 v[176:191], v[144:147], v[68:71], v[176:191]
    buffer_load_dwordx4 a[44:47], v2, s[32:35], s60 offen offset:3072
    s_add_u32 s60, s60, 4096
    ds_read_b128 v[144:147], v28 offset:10240
    s_waitcnt lgkmcnt(3)
    v_mfma_f32_32x32x16_bf16 v[192:207], v[148:151], v[68:71], v[192:207]
    ds_read_b128 v[148:151], v2 offset:11264
    s_waitcnt vmcnt(17) lgkmcnt(3)
    v_mfma_f32_32x32x16_bf16 v[160:175], v[152:155], v[72:75], v[160:175]
    buffer_load_dwordx4 v[128:131], v2, s[32:35], s74 offen sc1
    buffer_load_dwordx4 a[48:51], v2, s[32:35], s60 offen
    ds_read_b128 v[152:155], v2 offset:39936
    s_waitcnt lgkmcnt(3)
    v_mfma_f32_32x32x16_bf16 v[176:191], v[156:159], v[72:75], v[176:191]
    ds_read_b128 v[156:159], v28 offset:11264
    s_waitcnt lgkmcnt(3)
    v_mfma_f32_32x32x16_bf16 v[192:207], v[144:147], v[72:75], v[192:207]
    buffer_load_dwordx4 a[52:55], v2, s[32:35], s60 offen offset:1024
    ds_read_b128 v[144:147], v2 offset:12288
    s_waitcnt vmcnt(19) lgkmcnt(3)
    v_mfma_f32_32x32x16_bf16 v[160:175], v[148:151], v[76:79], v[160:175]
    buffer_load_dwordx4 v[132:135], v2, s[32:35], s74 offen offset:1024 sc1
    ds_read_b128 v[148:151], v2 offset:40960
    s_waitcnt lgkmcnt(3)
    v_mfma_f32_32x32x16_bf16 v[176:191], v[152:155], v[76:79], v[176:191]
    buffer_load_dwordx4 a[56:59], v2, s[32:35], s60 offen offset:2048
    ds_read_b128 v[152:155], v28 offset:12288
    s_waitcnt lgkmcnt(3)
    v_mfma_f32_32x32x16_bf16 v[192:207], v[156:159], v[76:79], v[192:207]
    ds_read_b128 v[156:159], v2 offset:13312
    s_waitcnt vmcnt(20) lgkmcnt(3)
    v_mfma_f32_32x32x16_bf16 v[160:175], v[144:147], v[80:83], v[160:175]
    buffer_load_dwordx4 v[136:139], v2, s[32:35], s74 offen offset:2048 sc1
    buffer_load_dwordx4 a[60:63], v2, s[32:35], s60 offen offset:3072
    s_add_u32 s60, s60, 4096
    ds_read_b128 v[144:147], v2 offset:41984
    s_waitcnt lgkmcnt(3)
    v_mfma_f32_32x32x16_bf16 v[176:191], v[148:151], v[80:83], v[176:191]
    ds_read_b128 v[148:151], v28 offset:13312
    s_waitcnt lgkmcnt(3)
    v_mfma_f32_32x32x16_bf16 v[192:207], v[152:155], v[80:83], v[192:207]
    buffer_load_dwordx4 a[64:67], v2, s[32:35], s60 offen
    ds_read_b128 v[152:155], v2 offset:14336
    s_waitcnt vmcnt(22) lgkmcnt(3)
    v_mfma_f32_32x32x16_bf16 v[160:175], v[156:159], v[84:87], v[160:175]
    buffer_load_dwordx4 v[140:143], v2, s[32:35], s74 offen offset:3072 sc1
    s_add_u32 s74, s74, 4096
    ds_read_b128 v[156:159], v2 offset:43008
    s_waitcnt lgkmcnt(3)
    v_mfma_f32_32x32x16_bf16 v[176:191], v[144:147], v[84:87], v[176:191]
    buffer_load_dwordx4 a[68:71], v2, s[32:35], s60 offen offset:1024
    ds_read_b128 v[144:147], v28 offset:14336
    s_waitcnt lgkmcnt(3)
    v_mfma_f32_32x32x16_bf16 v[192:207], v[148:151], v[84:87], v[192:207]
    ds_read_b128 v[148:151], v2 offset:15360
    s_waitcnt vmcnt(23) lgkmcnt(3)
    v_mfma_f32_32x32x16_bf16 v[160:175], v[152:155], v[88:91], v[160:175]
    buffer_load_dwordx2 v[224:225], v7, s[32:35], 0 offen sc1
    buffer_load_dwordx2 v[226:227], v7, s[32:35], 0 offen offset:256 sc1
    buffer_load_dwordx4 a[72:75], v2, s[32:35], s60 offen offset:2048
    ds_read_b128 v[152:155], v2 offset:44032
    s_waitcnt lgkmcnt(3)
    v_mfma_f32_32x32x16_bf16 v[176:191], v[156:159], v[88:91], v[176:191]
    ds_read_b128 v[156:159], v28 offset:15360
    s_waitcnt lgkmcnt(3)
    v_mfma_f32_32x32x16_bf16 v[192:207], v[144:147], v[88:91], v[192:207]
    buffer_load_dwordx4 a[76:79], v2, s[32:35], s60 offen offset:3072
    s_add_u32 s60, s60, 4096
    ds_read_b128 v[144:147], v2 offset:16384
    s_waitcnt vmcnt(26) lgkmcnt(3)
    v_mfma_f32_32x32x16_bf16 v[160:175], v[148:151], v[92:95], v[160:175]
    buffer_load_dwordx2 v[228:229], v7, s[32:35], 0 offen offset:512 sc1
    buffer_load_dwordx2 v[230:231], v7, s[32:35], 0 offen offset:768 sc1
    ds_read_b128 v[148:151], v2 offset:45056
    s_waitcnt lgkmcnt(3)
    v_mfma_f32_32x32x16_bf16 v[176:191], v[152:155], v[92:95], v[176:191]
    buffer_load_dwordx4 a[80:83], v2, s[32:35], s60 offen
    ds_read_b128 v[152:155], v28 offset:16384
    s_waitcnt lgkmcnt(3)
    v_mfma_f32_32x32x16_bf16 v[192:207], v[156:159], v[92:95], v[192:207]
    ds_read_b128 v[156:159], v2 offset:17408
    s_waitcnt vmcnt(28) lgkmcnt(3)
    v_mfma_f32_32x32x16_bf16 v[160:175], v[144:147], v[96:99], v[160:175]
    buffer_load_dwordx2 v[232:233], v7, s[32:35], 0 offen offset:1024 sc1
    buffer_load_dwordx2 v[234:235], v7, s[32:35], 0 offen offset:1280 sc1
    buffer_load_dwordx4 a[84:87], v2, s[32:35], s60 offen offset:1024
    ds_read_b128 v[144:147], v2 offset:46080
    s_waitcnt lgkmcnt(3)
    v_mfma_f32_32x32x16_bf16 v[176:191], v[148:151], v[96:99], v[176:191]
    ds_read_b128 v[148:151], v28 offset:17408
    s_waitcnt lgkmcnt(3)
    v_mfma_f32_32x32x16_bf16 v[192:207], v[152:155], v[96:99], v[192:207]
    buffer_load_dwordx4 a[88:91], v2, s[32:35], s60 offen offset:2048
    ds_read_b128 v[152:155], v2 offset:18432
    s_waitcnt vmcnt(31) lgkmcnt(3)
    v_mfma_f32_32x32x16_bf16 v[160:175], v[156:159], v[100:103], v[160:175]
    buffer_load_dwordx2 v[236:237], v7, s[32:35], 0 offen offset:1536 sc1
    ds_read_b128 v[156:159], v2 offset:47104
    s_waitcnt lgkmcnt(3)
    v_mfma_f32_32x32x16_bf16 v[176:191], v[144:147], v[100:103], v[176:191]
    buffer_load_dwordx4 a[92:95], v2, s[32:35], s60 offen offset:3072
    s_add_u32 s60, s60, 4096
    ds_read_b128 v[144:147], v28 offset:18432
    s_waitcnt lgkmcnt(3)
    v_mfma_f32_32x32x16_bf16 v[192:207], v[148:151], v[100:103], v[192:207]
    ds_read_b128 v[148:151], v2 offset:19456
    s_waitcnt vmcnt(32) lgkmcnt(3)
    v_mfma_f32_32x32x16_bf16 v[160:175], v[152:155], v[104:107], v[160:175]
    buffer_load_dwordx4 a[96:99], v2, s[32:35], s60 offen
    ds_read_b128 v[152:155], v2 offset:48128
    s_waitcnt lgkmcnt(3)
    v_mfma_f32_32x32x16_bf16 v[176:191], v[156:159], v[104:107], v[176:191]
    ds_read_b128 v[156:159], v28 offset:19456
    s_waitcnt lgkmcnt(3)
    v_mfma_f32_32x32x16_bf16 v[192:207], v[144:147], v[104:107], v[192:207]
    buffer_load_dwordx4 a[100:103], v2, s[32:35], s60 offen offset:1024
    ds_read_b128 v[144:147], v2 offset:20480
    s_waitcnt vmcnt(33) lgkmcnt(3)
    v_mfma_f32_32x32x16_bf16 v[160:175], v[148:151], v[108:111], v[160:175]
    ds_read_b128 v[148:151], v2 offset:49152
    s_waitcnt lgkmcnt(3)
    v_mfma_f32_32x32x16_bf16 v[176:191], v[152:155], v[108:111], v[176:191]
    buffer_load_dwordx4 a[104:107], v2, s[32:35], s60 offen offset:2048
    ds_read_b128 v[152:155], v28 offset:20480
    s_waitcnt lgkmcnt(3)
    v_mfma_f32_32x32x16_bf16 v[192:207], v[156:159], v[108:111], v[192:207]
    ds_read_b128 v[156:159], v2 offset:21504
    s_waitcnt vmcnt(33) lgkmcnt(3)
    v_mfma_f32_32x32x16_bf16 v[160:175], v[144:147], v[112:115], v[160:175]
    buffer_load_dwordx4 a[108:111], v2, s[32:35], s60 offen offset:3072
    s_add_u32 s60, s60, 4096
    ds_read_b128 v[144:147], v2 offset:50176
    s_waitcnt lgkmcnt(3)
    v_mfma_f32_32x32x16_bf16 v[176:191], v[148:151], v[112:115], v[176:191]
    ds_read_b128 v[148:151], v28 offset:21504
    s_waitcnt lgkmcnt(3)
    v_mfma_f32_32x32x16_bf16 v[192:207], v[152:155], v[112:115], v[192:207]
    buffer_load_dwordx4 a[112:115], v2, s[32:35], s60 offen
    ds_read_b128 v[152:155], v2 offset:22528
    s_waitcnt vmcnt(34) lgkmcnt(3)
    v_mfma_f32_32x32x16_bf16 v[160:175], v[156:159], v[116:119], v[160:175]
    ds_read_b128 v[156:159], v2 offset:51200
    s_waitcnt lgkmcnt(3)
    v_mfma_f32_32x32x16_bf16 v[176:191], v[144:147], v[116:119], v[176:191]
    buffer_load_dwordx4 a[116:119], v2, s[32:35], s60 offen offset:1024
    ds_read_b128 v[144:147], v28 offset:22528
    s_waitcnt lgkmcnt(3)
    v_mfma_f32_32x32x16_bf16 v[192:207], v[148:151], v[116:119], v[192:207]
    ds_read_b128 v[148:151], v2 offset:23552
    s_waitcnt vmcnt(33) lgkmcnt(3)
    v_mfma_f32_32x32x16_bf16 v[160:175], v[152:155], v[120:123], v[160:175]
    buffer_load_dwordx4 a[120:123], v2, s[32:35], s60 offen offset:2048
    ds_read_b128 v[152:155], v2 offset:52224
    s_waitcnt lgkmcnt(3)
    v_mfma_f32_32x32x16_bf16 v[176:191], v[156:159], v[120:123], v[176:191]
    ds_read_b128 v[156:159], v28 offset:23552
    s_waitcnt lgkmcnt(3)
    v_mfma_f32_32x32x16_bf16 v[192:207], v[144:147], v[120:123], v[192:207]
    buffer_load_dwordx4 a[124:127], v2, s[32:35], s60 offen offset:3072
    s_add_u32 s60, s60, 4096
    ds_read_b128 v[144:147], v2 offset:24576
    s_waitcnt vmcnt(32) lgkmcnt(3)
    v_mfma_f32_32x32x16_bf16 v[160:175], v[148:151], v[124:127], v[160:175]
    ds_read_b128 v[148:151], v2 offset:53248
    s_waitcnt lgkmcnt(3)
    v_mfma_f32_32x32x16_bf16 v[176:191], v[152:155], v[124:127], v[176:191]
    buffer_load_dwordx4 a[128:131], v2, s[32:35], s60 offen
    ds_read_b128 v[152:155], v28 offset:24576
    s_waitcnt lgkmcnt(3)
    v_mfma_f32_32x32x16_bf16 v[192:207], v[156:159], v[124:127], v[192:207]
    ds_read_b128 v[156:159], v2 offset:25600
    s_waitcnt vmcnt(31) lgkmcnt(3)
    v_mfma_f32_32x32x16_bf16 v[160:175], v[144:147], v[128:131], v[160:175]
    buffer_load_dwordx4 a[132:135], v2, s[32:35], s60 offen offset:1024
    ds_read_b128 v[144:147], v2 offset:54272
    s_waitcnt lgkmcnt(3)
    v_mfma_f32_32x32x16_bf16 v[176:191], v[148:151], v[128:131], v[176:191]
    ds_read_b128 v[148:151], v28 offset:25600
    s_waitcnt lgkmcnt(3)
    v_mfma_f32_32x32x16_bf16 v[192:207], v[152:155], v[128:131], v[192:207]
    buffer_load_dwordx4 a[136:139], v2, s[32:35], s60 offen offset:2048
    ds_read_b128 v[152:155], v2 offset:26624
    s_waitcnt vmcnt(30) lgkmcnt(3)
    v_mfma_f32_32x32x16_bf16 v[160:175], v[156:159], v[132:135], v[160:175]
    ds_read_b128 v[156:159], v2 offset:55296
    s_waitcnt lgkmcnt(3)
    v_mfma_f32_32x32x16_bf16 v[176:191], v[144:147], v[132:135], v[176:191]
    buffer_load_dwordx4 a[140:143], v2, s[32:35], s60 offen offset:3072
    s_add_u32 s60, s60, 4096
    ds_read_b128 v[144:147], v28 offset:26624
    s_waitcnt lgkmcnt(3)
    v_mfma_f32_32x32x16_bf16 v[192:207], v[148:151], v[132:135], v[192:207]
    ds_read_b128 v[148:151], v2 offset:27648
    s_waitcnt vmcnt(29) lgkmcnt(3)
    v_mfma_f32_32x32x16_bf16 v[160:175], v[152:155], v[136:139], v[160:175]
    buffer_load_dwordx4 a[144:147], v2, s[32:35], s60 offen
    ds_read_b128 v[152:155], v2 offset:56320
    s_waitcnt lgkmcnt(3)
    v_mfma_f32_32x32x16_bf16 v[176:191], v[156:159], v[136:139], v[176:191]
    ds_read_b128 v[156:159], v28 offset:27648
    s_waitcnt lgkmcnt(3)
    v_mfma_f32_32x32x16_bf16 v[192:207], v[144:147], v[136:139], v[192:207]
    buffer_load_dwordx4 a[148:151], v2, s[32:35], s60 offen offset:1024
    ds_read_b128 v[144:147], v28 offset:28672
    s_waitcnt vmcnt(28) lgkmcnt(3)
    v_mfma_f32_32x32x16_bf16 v[160:175], v[148:151], v[140:143], v[160:175]
    s_waitcnt vmcnt(25)
    v_add_f32 v224, v224, v226
    v_add_f32 v225, v225, v227
    s_waitcnt vmcnt(22)
    v_add_f32 v224, v224, v228
    v_add_f32 v225, v225, v229
    s_waitcnt vmcnt(21)
    v_add_f32 v224, v224, v230
    v_add_f32 v225, v225, v231
    s_waitcnt vmcnt(19)
    v_add_f32 v224, v224, v232
    v_add_f32 v225, v225, v233
    s_waitcnt vmcnt(18)
    v_add_f32 v224, v224, v234
    v_add_f32 v225, v225, v235
    s_waitcnt vmcnt(15)
    v_add_f32 v224, v224, v236
    v_add_f32 v225, v225, v237
    v_mov_b32 v3, v224
    v_mov_b32 v226, v224
    s_nop 1
    v_permlane32_swap_b32 v3, v226
    v_add_f32 v226, v226, v3
    v_mov_b32 v3, v225
    v_mov_b32 v227, v225
    s_nop 1
    v_permlane32_swap_b32 v3, v227
    v_add_f32 v227, v227, v3
    v_mul_f32 v228, 0xbb124925, v226
    v_mul_f32 v229, 0x3b124925, v227
    v_fma_f32 v229, -v228, v228, v229
    v_max_f32 v229, 0, v229
    v_add_f32 v229, 0x3727c5ac, v229
    v_rsq_f32 v231, v229
    s_nop 0
    v_mul_f32 v230, v229, v231
    v_cvt_pk_bf16_f32 v240, v228, v228
    v_lshlrev_b32 v3, 16, v240
    v_sub_f32 v3, v228, v3
    v_cvt_pk_bf16_f32 v241, v3, v230
    v_and_b32 v3, 0xffff0000, v241
    v_sub_f32 v3, v230, v3
    v_cvt_pk_bf16_f32 v242, v3, 0
    v_mov_b32 v243, 0
    v_mul_f32 v238, 0xc0135761, v231
    v_mul_f32 v3, v231, v231
    v_mul_f32 v3, v3, v231
    v_mul_f32 v244, 0xbdd2d3e8, v3
    s_lshl_b32 s49, s44, 7
    s_add_u32 s49, s49, 0x1c000
    v_lshl_add_u32 v3, v10, 2, s49
    ds_write_b32 v3, v231
    v_mfma_f32_32x32x16_bf16 v[160:175], a[224:227], v[240:243], v[160:175]
    ds_read_b128 v[148:151], v28 offset:29696
    s_waitcnt lgkmcnt(4)
    v_mfma_f32_32x32x16_bf16 v[176:191], v[152:155], v[140:143], v[176:191]
    v_mfma_f32_32x32x16_bf16 v[176:191], a[228:231], v[240:243], v[176:191]
    buffer_load_dwordx4 a[152:155], v2, s[32:35], s60 offen offset:2048
    ds_read_b128 v[152:155], v28 offset:30720
    s_waitcnt lgkmcnt(4)
    v_mfma_f32_32x32x16_bf16 v[192:207], v[156:159], v[140:143], v[192:207]
    v_mfma_f32_32x32x16_bf16 v[192:207], a[232:235], v[240:243], v[192:207]
    ds_read_b128 v[156:159], v28 offset:31744
    s_waitcnt lgkmcnt(4)
    v_mfma_f32_32x32x16_bf16 v[208:223], v[144:147], v[32:35], 0
    buffer_load_dwordx4 a[156:159], v2, s[32:35], s60 offen offset:3072
    s_add_u32 s60, s60, 4096
    ds_read_b128 v[144:147], v28 offset:32768
    s_waitcnt lgkmcnt(3)
    v_mfma_f32_32x32x16_bf16 v[208:223], v[148:151], v[36:39], v[208:223]
    v_mul_f32 v246, v160, v160
    v_mul_f32 v247, v161, v161
    v_mul_f32 v248, v162, v162
    v_mul_f32 v249, v163, v163
    v_fma_f32 v246, v246, v244, v238
    ds_read_b128 v[148:151], v28 offset:33792
    s_waitcnt lgkmcnt(3)
    v_mfma_f32_32x32x16_bf16 v[208:223], v[152:155], v[40:43], v[208:223]
    v_fma_f32 v247, v247, v244, v238
    v_fma_f32 v248, v248, v244, v238
    v_fma_f32 v249, v249, v244, v238
    v_mul_f32 v246, v246, v160
    v_mul_f32 v247, v247, v161
    buffer_load_dwordx4 a[160:163], v2, s[32:35], s60 offen
    ds_read_b128 v[152:155], v28 offset:34816
    s_waitcnt lgkmcnt(3)
    v_mfma_f32_32x32x16_bf16 v[208:223], v[156:159], v[44:47], v[208:223]
    v_mul_f32 v248, v248, v162
    v_mul_f32 v249, v249, v163
    v_exp_f32 v246, v246
    v_exp_f32 v247, v247
    ds_read_b128 v[156:159], v28 offset:35840
    s_waitcnt lgkmcnt(3)
    v_mfma_f32_32x32x16_bf16 v[208:223], v[144:147], v[48:51], v[208:223]
    v_exp_f32 v248, v248
    v_exp_f32 v249, v249
    v_add_f32 v246, 1.0, v246
    buffer_load_dwordx4 a[164:167], v2, s[32:35], s60 offen offset:1024
    ds_read_b128 v[144:147], v28 offset:36864
    s_waitcnt lgkmcnt(3)
    v_mfma_f32_32x32x16_bf16 v[208:223], v[148:151], v[52:55], v[208:223]
    v_add_f32 v247, 1.0, v247
    v_add_f32 v248, 1.0, v248
    v_add_f32 v249, 1.0, v249
    v_rcp_f32 v246, v246
    ds_read_b128 v[148:151], v28 offset:37888
    s_waitcnt lgkmcnt(3)
    v_mfma_f32_32x32x16_bf16 v[208:223], v[152:155], v[56:59], v[208:223]
    v_rcp_f32 v247, v247
    v_rcp_f32 v248, v248
    v_rcp_f32 v249, v249
    buffer_load_dwordx4 a[168:171], v2, s[32:35], s60 offen offset:2048
    ds_read_b128 v[152:155], v28 offset:38912
    s_waitcnt lgkmcnt(3)
    v_mfma_f32_32x32x16_bf16 v[208:223], v[156:159], v[60:63], v[208:223]
    v_mul_f32 v246, v246, v160
    v_mul_f32 v247, v247, v161
    v_mul_f32 v248, v248, v162
    v_mul_f32 v249, v249, v163
    v_cvt_pk_bf16_f32 v160, v246, v247
    ds_read_b128 v[156:159], v28 offset:39936
    s_waitcnt lgkmcnt(3)
    v_mfma_f32_32x32x16_bf16 v[208:223], v[144:147], v[64:67], v[208:223]
    v_cvt_pk_bf16_f32 v161, v248, v249
    v_mul_f32 v250, v164, v164
    v_mul_f32 v251, v165, v165
    v_mul_f32 v252, v166, v166
    v_mul_f32 v253, v167, v167
    buffer_load_dwordx4 a[172:175], v2, s[32:35], s60 offen offset:3072
    s_add_u32 s60, s60, 4096
    ds_read_b128 v[144:147], v28 offset:40960
    s_waitcnt lgkmcnt(3)
    v_mfma_f32_32x32x16_bf16 v[208:223], v[148:151], v[68:71], v[208:223]
    v_fma_f32 v250, v250, v244, v238
    v_fma_f32 v251, v251, v244, v238
    v_fma_f32 v252, v252, v244, v238
    v_fma_f32 v253, v253, v244, v238
    ds_read_b128 v[148:151], v28 offset:41984
    s_waitcnt lgkmcnt(3)
    v_mfma_f32_32x32x16_bf16 v[208:223], v[152:155], v[72:75], v[208:223]
    v_mul_f32 v250, v250, v164
    v_mul_f32 v251, v251, v165
    v_mul_f32 v252, v252, v166
    v_mul_f32 v253, v253, v167
    v_exp_f32 v250, v250
    buffer_load_dwordx4 a[176:179], v2, s[32:35], s60 offen
    ds_read_b128 v[152:155], v28 offset:43008
    s_waitcnt lgkmcnt(3)
    v_mfma_f32_32x32x16_bf16 v[208:223], v[156:159], v[76:79], v[208:223]
    v_exp_f32 v251, v251
    v_exp_f32 v252, v252
    v_exp_f32 v253, v253
    ds_read_b128 v[156:159], v28 offset:44032
    s_waitcnt lgkmcnt(3)
    v_mfma_f32_32x32x16_bf16 v[208:223], v[144:147], v[80:83], v[208:223]
    v_add_f32 v250, 1.0, v250
    v_add_f32 v251, 1.0, v251
    v_add_f32 v252, 1.0, v252
    v_add_f32 v253, 1.0, v253
    v_rcp_f32 v250, v250
    buffer_load_dwordx4 a[180:183], v2, s[32:35], s60 offen offset:1024
    ds_read_b128 v[144:147], v28 offset:45056
    s_waitcnt lgkmcnt(3)
    v_mfma_f32_32x32x16_bf16 v[208:223], v[148:151], v[84:87], v[208:223]
    v_rcp_f32 v251, v251
    v_rcp_f32 v252, v252
    v_rcp_f32 v253, v253
    ds_read_b128 v[148:151], v28 offset:46080
    s_waitcnt lgkmcnt(3)
    v_mfma_f32_32x32x16_bf16 v[208:223], v[152:155], v[88:91], v[208:223]
    v_mul_f32 v250, v250, v164
    v_mul_f32 v251, v251, v165
    v_mul_f32 v252, v252, v166
    v_mul_f32 v253, v253, v167
    v_cvt_pk_bf16_f32 v162, v250, v251
    buffer_load_dwordx4 a[184:187], v2, s[32:35], s60 offen offset:2048
    ds_read_b128 v[152:155], v28 offset:47104
    s_waitcnt lgkmcnt(3)
    v_mfma_f32_32x32x16_bf16 v[208:223], v[156:159], v[92:95], v[208:223]
    v_cvt_pk_bf16_f32 v163, v252, v253
    s_add_u32 s52, s75, 0
    buffer_store_dwordx4 v[160:163], v2, s[32:35], s52 offen sc1
    v_mul_f32 v246, v168, v168
    v_mul_f32 v247, v169, v169
    ds_read_b128 v[156:159], v28 offset:48128
    s_waitcnt lgkmcnt(3)
    v_mfma_f32_32x32x16_bf16 v[208:223], v[144:147], v[96:99], v[208:223]
    v_mul_f32 v248, v170, v170
    v_mul_f32 v249, v171, v171
    v_fma_f32 v246, v246, v244, v238
    v_fma_f32 v247, v247, v244, v238
    v_fma_f32 v248, v248, v244, v238
    buffer_load_dwordx4 a[188:191], v2, s[32:35], s60 offen offset:3072
    s_add_u32 s60, s60, 4096
    ds_read_b128 v[144:147], v28 offset:49152
    s_waitcnt lgkmcnt(3)
    v_mfma_f32_32x32x16_bf16 v[208:223], v[148:151], v[100:103], v[208:223]
    v_fma_f32 v249, v249, v244, v238
    v_mul_f32 v246, v246, v168
    v_mul_f32 v247, v247, v169
    v_mul_f32 v248, v248, v170
    v_mul_f32 v249, v249, v171
    ds_read_b128 v[148:151], v28 offset:50176
    s_waitcnt lgkmcnt(3)
    v_mfma_f32_32x32x16_bf16 v[208:223], v[152:155], v[104:107], v[208:223]
    v_exp_f32 v246, v246
    v_exp_f32 v247, v247
    v_exp_f32 v248, v248
    buffer_load_dwordx4 a[192:195], v2, s[32:35], s60 offen
    ds_read_b128 v[152:155], v28 offset:51200
    s_waitcnt lgkmcnt(3)
    v_mfma_f32_32x32x16_bf16 v[208:223], v[156:159], v[108:111], v[208:223]
    v_exp_f32 v249, v249
    v_add_f32 v246, 1.0, v246
    v_add_f32 v247, 1.0, v247
    v_add_f32 v248, 1.0, v248
    ds_read_b128 v[156:159], v28 offset:52224
    s_waitcnt lgkmcnt(3)
    v_mfma_f32_32x32x16_bf16 v[208:223], v[144:147], v[112:115], v[208:223]
    v_add_f32 v249, 1.0, v249
    v_rcp_f32 v246, v246
    v_rcp_f32 v247, v247
    buffer_load_dwordx4 a[196:199], v2, s[32:35], s60 offen offset:1024
    ds_read_b128 v[144:147], v28 offset:53248
    s_waitcnt lgkmcnt(3)
    v_mfma_f32_32x32x16_bf16 v[208:223], v[148:151], v[116:119], v[208:223]
    v_rcp_f32 v248, v248
    v_rcp_f32 v249, v249
    v_mul_f32 v246, v246, v168
    ds_read_b128 v[148:151], v28 offset:54272
    s_waitcnt lgkmcnt(3)
    v_mfma_f32_32x32x16_bf16 v[208:223], v[152:155], v[120:123], v[208:223]
    v_mul_f32 v247, v247, v169
    v_mul_f32 v248, v248, v170
    v_mul_f32 v249, v249, v171
    v_cvt_pk_bf16_f32 v164, v246, v247
    v_cvt_pk_bf16_f32 v165, v248, v249
    buffer_load_dwordx4 a[200:203], v2, s[32:35], s60 offen offset:2048
    ds_read_b128 v[152:155], v28 offset:55296
    s_waitcnt lgkmcnt(3)
    v_mfma_f32_32x32x16_bf16 v[208:223], v[156:159], v[124:127], v[208:223]
    v_mul_f32 v250, v172, v172
    v_mul_f32 v251, v173, v173
    v_mul_f32 v252, v174, v174
    v_mul_f32 v253, v175, v175
    v_fma_f32 v250, v250, v244, v238
    ds_read_b128 v[156:159], v28 offset:56320
    s_waitcnt lgkmcnt(3)
    v_mfma_f32_32x32x16_bf16 v[208:223], v[144:147], v[128:131], v[208:223]
    v_fma_f32 v251, v251, v244, v238
    v_fma_f32 v252, v252, v244, v238
    v_fma_f32 v253, v253, v244, v238
    v_mul_f32 v250, v250, v172
    v_mul_f32 v251, v251, v173
    buffer_load_dwordx4 a[204:207], v2, s[32:35], s60 offen offset:3072
    s_add_u32 s60, s60, 4096
    s_waitcnt lgkmcnt(2)
    v_mfma_f32_32x32x16_bf16 v[208:223], v[148:151], v[132:135], v[208:223]
    v_mul_f32 v252, v252, v174
    v_mul_f32 v253, v253, v175
    v_exp_f32 v250, v250
    v_exp_f32 v251, v251
    s_waitcnt lgkmcnt(1)
    v_mfma_f32_32x32x16_bf16 v[208:223], v[152:155], v[136:139], v[208:223]
    v_exp_f32 v252, v252
    v_exp_f32 v253, v253
    v_add_f32 v250, 1.0, v250
    buffer_load_dwordx4 a[208:211], v2, s[32:35], s60 offen
    s_waitcnt lgkmcnt(0)
    v_mfma_f32_32x32x16_bf16 v[208:223], v[156:159], v[140:143], v[208:223]
    v_mfma_f32_32x32x16_bf16 v[208:223], a[236:239], v[240:243], v[208:223]
    v_add_f32 v251, 1.0, v251
    v_add_f32 v252, 1.0, v252
    v_add_f32 v253, 1.0, v253
    v_rcp_f32 v250, v250
    v_min_u32 v254, 13, v1
    v_lshlrev_b32 v254, 7, v254
    v_rcp_f32 v251, v251
    v_rcp_f32 v252, v252
    v_rcp_f32 v253, v253
    v_mul_f32 v250, v250, v172
    v_mul_f32 v251, v251, v173
    v_mul_f32 v252, v252, v174
    v_mul_f32 v253, v253, v175
    buffer_load_dwordx4 a[212:215], v2, s[32:35], s60 offen offset:1024
    v_cvt_pk_bf16_f32 v166, v250, v251
    v_cvt_pk_bf16_f32 v167, v252, v253
    s_add_u32 s52, s75, 57344
    buffer_store_dwordx4 v[164:167], v2, s[32:35], s52 offen sc1
    v_pk_mul_f32 v[246:247], v[176:177], v[176:177]
    v_pk_mul_f32 v[248:249], v[178:179], v[178:179]
    v_pk_fma_f32 v[246:247], v[246:247], v[244:245], v[238:239] op_sel_hi:[1,0,0]
    v_pk_fma_f32 v[248:249], v[248:249], v[244:245], v[238:239] op_sel_hi:[1,0,0]
    v_pk_mul_f32 v[246:247], v[246:247], v[176:177]
    v_pk_mul_f32 v[248:249], v[248:249], v[178:179]
    v_exp_f32 v246, v246
    v_exp_f32 v247, v247
    v_exp_f32 v248, v248
    v_exp_f32 v249, v249
    buffer_load_dwordx4 a[216:219], v2, s[32:35], s60 offen offset:2048
    v_pk_add_f32 v[246:247], v[246:247], s[66:67]
    v_pk_add_f32 v[248:249], v[248:249], s[66:67]
    v_rcp_f32 v246, v246
    v_rcp_f32 v247, v247
    v_rcp_f32 v248, v248
    v_rcp_f32 v249, v249
    v_pk_mul_f32 v[246:247], v[246:247], v[176:177]
    v_pk_mul_f32 v[248:249], v[248:249], v[178:179]
    v_cvt_pk_bf16_f32 v176, v246, v247
    v_cvt_pk_bf16_f32 v177, v248, v249
    v_pk_mul_f32 v[250:251], v[180:181], v[180:181]
    v_pk_mul_f32 v[252:253], v[182:183], v[182:183]
    v_pk_fma_f32 v[250:251], v[250:251], v[244:245], v[238:239] op_sel_hi:[1,0,0]
    v_pk_fma_f32 v[252:253], v[252:253], v[244:245], v[238:239] op_sel_hi:[1,0,0]
    buffer_load_dwordx4 a[220:223], v2, s[32:35], s60 offen offset:3072
    s_add_u32 s60, s60, 4096
    v_pk_mul_f32 v[250:251], v[250:251], v[180:181]
    v_pk_mul_f32 v[252:253], v[252:253], v[182:183]
    v_exp_f32 v250, v250
    v_exp_f32 v251, v251
    v_exp_f32 v252, v252
    v_exp_f32 v253, v253
    v_pk_add_f32 v[250:251], v[250:251], s[66:67]
    v_pk_add_f32 v[252:253], v[252:253], s[66:67]
    v_rcp_f32 v250, v250
    v_rcp_f32 v251, v251
    v_rcp_f32 v252, v252
    v_rcp_f32 v253, v253
    v_pk_mul_f32 v[250:251], v[250:251], v[180:181]
    v_pk_mul_f32 v[252:253], v[252:253], v[182:183]
    v_cvt_pk_bf16_f32 v178, v250, v251
    v_cvt_pk_bf16_f32 v179, v252, v253
    s_add_u32 s52, s76, 114688
    buffer_store_dwordx4 v[176:179], v2, s[32:35], s52 offen sc1
    v_pk_mul_f32 v[246:247], v[184:185], v[184:185]
    v_pk_mul_f32 v[248:249], v[186:187], v[186:187]
    v_pk_fma_f32 v[246:247], v[246:247], v[244:245], v[238:239] op_sel_hi:[1,0,0]
    v_pk_fma_f32 v[248:249], v[248:249], v[244:245], v[238:239] op_sel_hi:[1,0,0]
    v_pk_mul_f32 v[246:247], v[246:247], v[184:185]
    v_pk_mul_f32 v[248:249], v[248:249], v[186:187]
    v_exp_f32 v246, v246
    v_exp_f32 v247, v247
    v_exp_f32 v248, v248
    v_exp_f32 v249, v249
    v_pk_add_f32 v[246:247], v[246:247], s[66:67]
    v_pk_add_f32 v[248:249], v[248:249], s[66:67]
    v_rcp_f32 v246, v246
    v_rcp_f32 v247, v247
    v_rcp_f32 v248, v248
    v_rcp_f32 v249, v249
    v_pk_mul_f32 v[246:247], v[246:247], v[184:185]
    v_pk_mul_f32 v[248:249], v[248:249], v[186:187]
    v_cvt_pk_bf16_f32 v180, v246, v247
    v_cvt_pk_bf16_f32 v181, v248, v249
    v_pk_mul_f32 v[250:251], v[188:189], v[188:189]
    v_pk_mul_f32 v[252:253], v[190:191], v[190:191]
    v_pk_fma_f32 v[250:251], v[250:251], v[244:245], v[238:239] op_sel_hi:[1,0,0]
    v_pk_fma_f32 v[252:253], v[252:253], v[244:245], v[238:239] op_sel_hi:[1,0,0]
    v_pk_mul_f32 v[250:251], v[250:251], v[188:189]
    v_pk_mul_f32 v[252:253], v[252:253], v[190:191]
    v_exp_f32 v250, v250
    v_exp_f32 v251, v251
    v_exp_f32 v252, v252
    v_exp_f32 v253, v253
    v_pk_add_f32 v[250:251], v[250:251], s[66:67]
    v_pk_add_f32 v[252:253], v[252:253], s[66:67]
    v_rcp_f32 v250, v250
    v_rcp_f32 v251, v251
    v_rcp_f32 v252, v252
    v_rcp_f32 v253, v253
    v_pk_mul_f32 v[250:251], v[250:251], v[188:189]
    v_pk_mul_f32 v[252:253], v[252:253], v[190:191]
    v_cvt_pk_bf16_f32 v182, v250, v251
    v_cvt_pk_bf16_f32 v183, v252, v253
    s_add_u32 s52, s76, 172032
    buffer_store_dwordx4 v[180:183], v2, s[32:35], s52 offen sc1
    v_pk_mul_f32 v[246:247], v[192:193], v[192:193]
    v_pk_mul_f32 v[248:249], v[194:195], v[194:195]
    v_pk_fma_f32 v[246:247], v[246:247], v[244:245], v[238:239] op_sel_hi:[1,0,0]
    v_pk_fma_f32 v[248:249], v[248:249], v[244:245], v[238:239] op_sel_hi:[1,0,0]
    v_pk_mul_f32 v[246:247], v[246:247], v[192:193]
    v_pk_mul_f32 v[248:249], v[248:249], v[194:195]
    v_exp_f32 v246, v246
    v_exp_f32 v247, v247
    v_exp_f32 v248, v248
    v_exp_f32 v249, v249
    v_pk_add_f32 v[246:247], v[246:247], s[66:67]
    v_pk_add_f32 v[248:249], v[248:249], s[66:67]
    v_rcp_f32 v246, v246
    v_rcp_f32 v247, v247
    v_rcp_f32 v248, v248
    v_rcp_f32 v249, v249
    v_pk_mul_f32 v[246:247], v[246:247], v[192:193]
    v_pk_mul_f32 v[248:249], v[248:249], v[194:195]
    v_cvt_pk_bf16_f32 v192, v246, v247
    v_cvt_pk_bf16_f32 v193, v248, v249
    v_pk_mul_f32 v[250:251], v[196:197], v[196:197]
    v_pk_mul_f32 v[252:253], v[198:199], v[198:199]
    v_pk_fma_f32 v[250:251], v[250:251], v[244:245], v[238:239] op_sel_hi:[1,0,0]
    s_waitcnt vmcnt(0)
    s_add_u32 s49, s56, 32768
    v_mov_b32 v3, 0x1c404
    s_mov_b64 exec, 1
    ds_add_rtn_u32 v4, v3, v11
    s_mov_b64 exec, -1
    s_waitcnt lgkmcnt(0)
    v_readfirstlane_b32 s50, v4
    s_nop 0
    s_cmp_eq_u32 s50, 3
    s_cselect_b32 s49, s49, 0x7f000000
    buffer_store_dword v11, v30, s[32:35], s49 offen sc1
    v_pk_fma_f32 v[252:253], v[252:253], v[244:245], v[238:239] op_sel_hi:[1,0,0]
    v_pk_mul_f32 v[250:251], v[250:251], v[196:197]
    v_pk_mul_f32 v[252:253], v[252:253], v[198:199]
    v_exp_f32 v250, v250
    v_exp_f32 v251, v251
    v_exp_f32 v252, v252
    v_exp_f32 v253, v253
    v_pk_add_f32 v[250:251], v[250:251], s[66:67]
    v_pk_add_f32 v[252:253], v[252:253], s[66:67]
    v_rcp_f32 v250, v250
    v_rcp_f32 v251, v251
    v_rcp_f32 v252, v252
    v_rcp_f32 v253, v253
    v_pk_mul_f32 v[250:251], v[250:251], v[196:197]
    v_pk_mul_f32 v[252:253], v[252:253], v[198:199]
    v_cvt_pk_bf16_f32 v194, v250, v251
    v_cvt_pk_bf16_f32 v195, v252, v253
    s_add_u32 s52, s75, 28672
    buffer_store_dwordx4 v[192:195], v2, s[32:35], s52 offen sc1
    v_pk_mul_f32 v[246:247], v[200:201], v[200:201]
    v_pk_mul_f32 v[248:249], v[202:203], v[202:203]
    v_pk_fma_f32 v[246:247], v[246:247], v[244:245], v[238:239] op_sel_hi:[1,0,0]
    v_pk_fma_f32 v[248:249], v[248:249], v[244:245], v[238:239] op_sel_hi:[1,0,0]
    v_pk_mul_f32 v[246:247], v[246:247], v[200:201]
    v_pk_mul_f32 v[248:249], v[248:249], v[202:203]
    v_exp_f32 v246, v246
    v_exp_f32 v247, v247
    v_exp_f32 v248, v248
    v_exp_f32 v249, v249
    v_pk_add_f32 v[246:247], v[246:247], s[66:67]
    v_pk_add_f32 v[248:249], v[248:249], s[66:67]
    v_rcp_f32 v246, v246
    v_rcp_f32 v247, v247
    v_rcp_f32 v248, v248
    v_rcp_f32 v249, v249
    v_pk_mul_f32 v[246:247], v[246:247], v[200:201]
    v_pk_mul_f32 v[248:249], v[248:249], v[202:203]
    v_cvt_pk_bf16_f32 v196, v246, v247
    v_cvt_pk_bf16_f32 v197, v248, v249
    v_pk_mul_f32 v[250:251], v[204:205], v[204:205]
    v_pk_mul_f32 v[252:253], v[206:207], v[206:207]
    v_pk_fma_f32 v[250:251], v[250:251], v[244:245], v[238:239] op_sel_hi:[1,0,0]
    v_pk_fma_f32 v[252:253], v[252:253], v[244:245], v[238:239] op_sel_hi:[1,0,0]
    v_pk_mul_f32 v[250:251], v[250:251], v[204:205]
    v_pk_mul_f32 v[252:253], v[252:253], v[206:207]
    v_exp_f32 v250, v250
    v_exp_f32 v251, v251
    v_exp_f32 v252, v252
    v_exp_f32 v253, v253
    v_pk_add_f32 v[250:251], v[250:251], s[66:67]
    v_pk_add_f32 v[252:253], v[252:253], s[66:67]
    v_rcp_f32 v250, v250
    v_rcp_f32 v251, v251
    v_rcp_f32 v252, v252
    v_rcp_f32 v253, v253
    v_pk_mul_f32 v[250:251], v[250:251], v[204:205]
    v_pk_mul_f32 v[252:253], v[252:253], v[206:207]
    v_cvt_pk_bf16_f32 v198, v250, v251
    v_cvt_pk_bf16_f32 v199, v252, v253
    s_add_u32 s52, s75, 86016
    buffer_store_dwordx4 v[196:199], v2, s[32:35], s52 offen sc1
    v_pk_mul_f32 v[246:247], v[208:209], v[208:209]
    v_pk_mul_f32 v[248:249], v[210:211], v[210:211]
    v_pk_fma_f32 v[246:247], v[246:247], v[244:245], v[238:239] op_sel_hi:[1,0,0]
    v_pk_fma_f32 v[248:249], v[248:249], v[244:245], v[238:239] op_sel_hi:[1,0,0]
    v_pk_mul_f32 v[246:247], v[246:247], v[208:209]
    v_pk_mul_f32 v[248:249], v[248:249], v[210:211]
    v_exp_f32 v246, v246
    v_exp_f32 v247, v247
    v_exp_f32 v248, v248
    v_exp_f32 v249, v249
    v_pk_add_f32 v[246:247], v[246:247], s[66:67]
    v_pk_add_f32 v[248:249], v[248:249], s[66:67]
    v_rcp_f32 v246, v246
    v_rcp_f32 v247, v247
    v_rcp_f32 v248, v248
    v_rcp_f32 v249, v249
    v_pk_mul_f32 v[246:247], v[246:247], v[208:209]
    v_pk_mul_f32 v[248:249], v[248:249], v[210:211]
    v_cvt_pk_bf16_f32 v208, v246, v247
    v_cvt_pk_bf16_f32 v209, v248, v249
    v_pk_mul_f32 v[250:251], v[212:213], v[212:213]
    v_pk_mul_f32 v[252:253], v[214:215], v[214:215]
    v_pk_fma_f32 v[250:251], v[250:251], v[244:245], v[238:239] op_sel_hi:[1,0,0]
    v_pk_fma_f32 v[252:253], v[252:253], v[244:245], v[238:239] op_sel_hi:[1,0,0]
    v_pk_mul_f32 v[250:251], v[250:251], v[212:213]
    v_pk_mul_f32 v[252:253], v[252:253], v[214:215]
    v_exp_f32 v250, v250
    v_exp_f32 v251, v251
    v_exp_f32 v252, v252
    v_exp_f32 v253, v253
    v_pk_add_f32 v[250:251], v[250:251], s[66:67]
    v_pk_add_f32 v[252:253], v[252:253], s[66:67]
    v_rcp_f32 v250, v250
    v_rcp_f32 v251, v251
    v_rcp_f32 v252, v252
    v_rcp_f32 v253, v253
    v_pk_mul_f32 v[250:251], v[250:251], v[212:213]
    v_pk_mul_f32 v[252:253], v[252:253], v[214:215]
    v_cvt_pk_bf16_f32 v210, v250, v251
    v_cvt_pk_bf16_f32 v211, v252, v253
    s_add_u32 s52, s76, 143360
    buffer_store_dwordx4 v[208:211], v2, s[32:35], s52 offen sc1
    v_pk_mul_f32 v[246:247], v[216:217], v[216:217]
    v_pk_mul_f32 v[248:249], v[218:219], v[218:219]
    s_add_u32 s63, s62, 32768
    buffer_load_dword v255, v254, s[32:35], s63 offen sc1
    v_pk_fma_f32 v[246:247], v[246:247], v[244:245], v[238:239] op_sel_hi:[1,0,0]
    v_pk_fma_f32 v[248:249], v[248:249], v[244:245], v[238:239] op_sel_hi:[1,0,0]
    v_pk_mul_f32 v[246:247], v[246:247], v[216:217]
    v_pk_mul_f32 v[248:249], v[248:249], v[218:219]
    v_exp_f32 v246, v246
    v_exp_f32 v247, v247
    v_exp_f32 v248, v248
    v_exp_f32 v249, v249
    v_pk_add_f32 v[246:247], v[246:247], s[66:67]
    v_pk_add_f32 v[248:249], v[248:249], s[66:67]
    v_rcp_f32 v246, v246
    v_rcp_f32 v247, v247
    v_rcp_f32 v248, v248
    v_rcp_f32 v249, v249
    v_pk_mul_f32 v[246:247], v[246:247], v[216:217]
    v_pk_mul_f32 v[248:249], v[248:249], v[218:219]
    v_cvt_pk_bf16_f32 v212, v246, v247
    v_cvt_pk_bf16_f32 v213, v248, v249
    v_pk_mul_f32 v[250:251], v[220:221], v[220:221]
    v_pk_mul_f32 v[252:253], v[222:223], v[222:223]
    v_pk_fma_f32 v[250:251], v[250:251], v[244:245], v[238:239] op_sel_hi:[1,0,0]
    v_pk_fma_f32 v[252:253], v[252:253], v[244:245], v[238:239] op_sel_hi:[1,0,0]
    v_pk_mul_f32 v[250:251], v[250:251], v[220:221]
    v_pk_mul_f32 v[252:253], v[252:253], v[222:223]
    v_exp_f32 v250, v250
    v_exp_f32 v251, v251
    v_exp_f32 v252, v252
    v_exp_f32 v253, v253
    v_pk_add_f32 v[250:251], v[250:251], s[66:67]
    v_pk_add_f32 v[252:253], v[252:253], s[66:67]
    v_rcp_f32 v250, v250
    v_rcp_f32 v251, v251
    v_rcp_f32 v252, v252
    v_rcp_f32 v253, v253
    v_pk_mul_f32 v[250:251], v[250:251], v[220:221]
    v_pk_mul_f32 v[252:253], v[252:253], v[222:223]
    v_cvt_pk_bf16_f32 v214, v250, v251
    v_cvt_pk_bf16_f32 v215, v252, v253
    s_add_u32 s52, s76, 200704
    buffer_store_dwordx4 v[212:215], v2, s[32:35], s52 offen sc1
    s_waitcnt vmcnt(1)
    v_cmp_ne_u32 vcc, 1, v255
    s_mov_b32 s55, 0
    s_nop 1
    s_cbranch_vccz K2_OKB
K2_POLLB:
    buffer_load_dword v255, v254, s[32:35], s63 offen sc1
    s_waitcnt vmcnt(0)
    v_cmp_ne_u32 vcc, 1, v255
    s_add_u32 s55, s55, 1
    s_cmp_gt_u32 s55, 0x40000
    s_cbranch_scc1 K2_OKB
    s_nop 1
    s_cbranch_vccnz K2_POLLB
K2_OKB:
    s_waitcnt vmcnt(0)
    s_add_u32 s49, s56, 65536
    v_mov_b32 v3, 0x1c408
    s_mov_b64 exec, 1
    ds_add_rtn_u32 v4, v3, v11
    s_mov_b64 exec, -1
    s_waitcnt lgkmcnt(0)
    v_readfirstlane_b32 s50, v4
    s_nop 0
    s_cmp_eq_u32 s50, 3
    s_cselect_b32 s49, s49, 0x7f000000
    buffer_store_dword v11, v30, s[32:35], s49 offen sc1
    buffer_load_dwordx4 v[32:35], v2, s[32:35], s61 offen sc1
    buffer_load_dwordx4 v[36:39], v2, s[32:35], s61 offen offset:1024 sc1
    buffer_load_dwordx4 v[40:43], v2, s[32:35], s61 offen offset:2048 sc1
    buffer_load_dwordx4 v[44:47], v2, s[32:35], s61 offen offset:3072 sc1
    s_add_u32 s61, s61, 4096
    buffer_load_dwordx4 v[48:51], v2, s[32:35], s61 offen sc1
    buffer_load_dwordx4 v[52:55], v2, s[32:35], s61 offen offset:1024 sc1
    buffer_load_dwordx4 v[56:59], v2, s[32:35], s61 offen offset:2048 sc1
    buffer_load_dwordx4 v[60:63], v2, s[32:35], s61 offen offset:3072 sc1
    s_add_u32 s61, s61, 4096
    buffer_load_dwordx4 v[64:67], v2, s[32:35], s61 offen sc1
    buffer_load_dwordx4 v[68:71], v2, s[32:35], s61 offen offset:1024 sc1
    buffer_load_dwordx4 v[72:75], v2, s[32:35], s61 offen offset:2048 sc1
    buffer_load_dwordx4 v[76:79], v2, s[32:35], s61 offen offset:3072 sc1
    s_add_u32 s61, s61, 4096
    s_waitcnt vmcnt(11)
    v_mfma_f32_32x32x16_bf16 v[160:175], a[0:3], v[32:35], 0
    v_mfma_f32_32x32x16_bf16 v[176:191], a[4:7], v[32:35], 0
    buffer_load_dwordx4 v[80:83], v2, s[32:35], s61 offen sc1
    s_waitcnt vmcnt(11)
    v_mfma_f32_32x32x16_bf16 v[192:207], a[0:3], v[36:39], 0
    v_mfma_f32_32x32x16_bf16 v[208:223], a[4:7], v[36:39], 0
    buffer_load_dwordx4 v[84:87], v2, s[32:35], s61 offen offset:1024 sc1
    s_waitcnt vmcnt(11)
    v_mfma_f32_32x32x16_bf16 v[160:175], a[8:11], v[40:43], v[160:175]
    v_mfma_f32_32x32x16_bf16 v[176:191], a[12:15], v[40:43], v[176:191]
    buffer_load_dwordx4 v[88:91], v2, s[32:35], s61 offen offset:2048 sc1
    s_waitcnt vmcnt(11)
    v_mfma_f32_32x32x16_bf16 v[192:207], a[8:11], v[44:47], v[192:207]
    v_mfma_f32_32x32x16_bf16 v[208:223], a[12:15], v[44:47], v[208:223]
    buffer_load_dwordx4 v[92:95], v2, s[32:35], s61 offen offset:3072 sc1
    s_add_u32 s61, s61, 4096
    s_waitcnt vmcnt(11)
    v_mfma_f32_32x32x16_bf16 v[160:175], a[16:19], v[48:51], v[160:175]
    v_lshlrev_b32 v224, 16, v12
    v_mfma_f32_32x32x16_bf16 v[176:191], a[20:23], v[48:51], v[176:191]
    v_and_b32 v225, 0xffff0000, v12
    buffer_load_dwordx4 v[96:99], v2, s[32:35], s61 offen sc1
    s_waitcnt vmcnt(11)
    v_mfma_f32_32x32x16_bf16 v[192:207], a[16:19], v[52:55], v[192:207]
    v_lshlrev_b32 v5, 16, v20
    v_mfma_f32_32x32x16_bf16 v[208:223], a[20:23], v[52:55], v[208:223]
    v_and_b32 v6, 0xffff0000, v20
    buffer_load_dwordx4 v[100:103], v2, s[32:35], s61 offen offset:1024 sc1
    s_waitcnt vmcnt(11)
    v_mfma_f32_32x32x16_bf16 v[160:175], a[24:27], v[56:59], v[160:175]
    v_add_f32 v224, v224, v5
    v_mfma_f32_32x32x16_bf16 v[176:191], a[28:31], v[56:59], v[176:191]
    v_add_f32 v225, v225, v6
    buffer_load_dwordx4 v[104:107], v2, s[32:35], s61 offen offset:2048 sc1
    s_waitcnt vmcnt(11)
    v_mfma_f32_32x32x16_bf16 v[192:207], a[24:27], v[60:63], v[192:207]
    v_lshlrev_b32 v226, 16, v13
    v_mfma_f32_32x32x16_bf16 v[208:223], a[28:31], v[60:63], v[208:223]
    v_and_b32 v227, 0xffff0000, v13
    buffer_load_dwordx4 v[108:111], v2, s[32:35], s61 offen offset:3072 sc1
    s_add_u32 s61, s61, 4096
    s_waitcnt vmcnt(11)
    v_mfma_f32_32x32x16_bf16 v[160:175], a[32:35], v[64:67], v[160:175]
    v_lshlrev_b32 v5, 16, v21
    v_mfma_f32_32x32x16_bf16 v[176:191], a[36:39], v[64:67], v[176:191]
    v_and_b32 v6, 0xffff0000, v21
    buffer_load_dwordx4 v[112:115], v2, s[32:35], s61 offen sc1
    s_waitcnt vmcnt(11)
    v_mfma_f32_32x32x16_bf16 v[192:207], a[32:35], v[68:71], v[192:207]
    v_add_f32 v226, v226, v5
    v_mfma_f32_32x32x16_bf16 v[208:223], a[36:39], v[68:71], v[208:223]
    v_add_f32 v227, v227, v6
    buffer_load_dwordx4 v[116:119], v2, s[32:35], s61 offen offset:1024 sc1
    s_waitcnt vmcnt(11)
    v_mfma_f32_32x32x16_bf16 v[160:175], a[40:43], v[72:75], v[160:175]
    v_lshlrev_b32 v228, 16, v14
    v_mfma_f32_32x32x16_bf16 v[176:191], a[44:47], v[72:75], v[176:191]
    v_and_b32 v229, 0xffff0000, v14
    buffer_load_dwordx4 v[120:123], v2, s[32:35], s61 offen offset:2048 sc1
    s_waitcnt vmcnt(11)
    v_mfma_f32_32x32x16_bf16 v[192:207], a[40:43], v[76:79], v[192:207]
    v_lshlrev_b32 v5, 16, v22
    v_mfma_f32_32x32x16_bf16 v[208:223], a[44:47], v[76:79], v[208:223]
    v_and_b32 v6, 0xffff0000, v22
    buffer_load_dwordx4 v[124:127], v2, s[32:35], s61 offen offset:3072 sc1
    s_add_u32 s61, s61, 4096
    s_add_u32 s63, s62, 65536
    buffer_load_dword v255, v254, s[32:35], s63 offen sc1
    s_waitcnt vmcnt(12)
    v_mfma_f32_32x32x16_bf16 v[160:175], a[48:51], v[80:83], v[160:175]
    v_add_f32 v228, v228, v5
    v_mfma_f32_32x32x16_bf16 v[176:191], a[52:55], v[80:83], v[176:191]
    v_add_f32 v229, v229, v6
    buffer_load_dwordx4 v[128:131], v2, s[32:35], s61 offen sc1
    s_waitcnt vmcnt(12)
    v_mfma_f32_32x32x16_bf16 v[192:207], a[48:51], v[84:87], v[192:207]
    v_lshlrev_b32 v230, 16, v15
    v_mfma_f32_32x32x16_bf16 v[208:223], a[52:55], v[84:87], v[208:223]
    v_and_b32 v231, 0xffff0000, v15
    buffer_load_dwordx4 v[132:135], v2, s[32:35], s61 offen offset:1024 sc1
    s_waitcnt vmcnt(12)
    v_mfma_f32_32x32x16_bf16 v[160:175], a[56:59], v[88:91], v[160:175]
    v_lshlrev_b32 v5, 16, v23
    v_mfma_f32_32x32x16_bf16 v[176:191], a[60:63], v[88:91], v[176:191]
    v_and_b32 v6, 0xffff0000, v23
    buffer_load_dwordx4 v[136:139], v2, s[32:35], s61 offen offset:2048 sc1
    s_waitcnt vmcnt(12)
    v_mfma_f32_32x32x16_bf16 v[192:207], a[56:59], v[92:95], v[192:207]
    v_add_f32 v230, v230, v5
    v_mfma_f32_32x32x16_bf16 v[208:223], a[60:63], v[92:95], v[208:223]
    v_add_f32 v231, v231, v6
    buffer_load_dwordx4 v[140:143], v2, s[32:35], s61 offen offset:3072 sc1
    s_add_u32 s61, s61, 4096
    s_waitcnt vmcnt(12)
    v_mfma_f32_32x32x16_bf16 v[160:175], a[64:67], v[96:99], v[160:175]
    v_lshlrev_b32 v232, 16, v16
    v_mfma_f32_32x32x16_bf16 v[176:191], a[68:71], v[96:99], v[176:191]
    v_and_b32 v233, 0xffff0000, v16
    s_waitcnt vmcnt(4)
    v_cmp_ne_u32 vcc, 1, v255
    s_mov_b32 s55, 0
    s_nop 1
    s_cbranch_vccz K2_OKC
K2_POLLC:
    buffer_load_dword v255, v254, s[32:35], s63 offen sc1
    s_waitcnt vmcnt(0)
    v_cmp_ne_u32 vcc, 1, v255
    s_add_u32 s55, s55, 1
    s_cmp_gt_u32 s55, 0x40000
    s_cbranch_scc1 K2_OKC
    s_nop 1
    s_cbranch_vccnz K2_POLLC
K2_OKC:
    buffer_load_dwordx4 v[32:35], v2, s[32:35], s61 offen sc1
    v_mfma_f32_32x32x16_bf16 v[192:207], a[64:67], v[100:103], v[192:207]
    v_lshlrev_b32 v5, 16, v24
    v_mfma_f32_32x32x16_bf16 v[208:223], a[68:71], v[100:103], v[208:223]
    v_and_b32 v6, 0xffff0000, v24
    buffer_load_dwordx4 v[36:39], v2, s[32:35], s61 offen offset:1024 sc1
    v_mfma_f32_32x32x16_bf16 v[160:175], a[72:75], v[104:107], v[160:175]
    v_add_f32 v232, v232, v5
    v_mfma_f32_32x32x16_bf16 v[176:191], a[76:79], v[104:107], v[176:191]
    v_add_f32 v233, v233, v6
    buffer_load_dwordx4 v[40:43], v2, s[32:35], s61 offen offset:2048 sc1
    v_mfma_f32_32x32x16_bf16 v[192:207], a[72:75], v[108:111], v[192:207]
    v_lshlrev_b32 v234, 16, v17
    v_mfma_f32_32x32x16_bf16 v[208:223], a[76:79], v[108:111], v[208:223]
    v_and_b32 v235, 0xffff0000, v17
    buffer_load_dwordx4 v[44:47], v2, s[32:35], s61 offen offset:3072 sc1
    s_add_u32 s61, s61, 4096
    v_mfma_f32_32x32x16_bf16 v[160:175], a[80:83], v[112:115], v[160:175]
    v_lshlrev_b32 v5, 16, v25
    v_mfma_f32_32x32x16_bf16 v[176:191], a[84:87], v[112:115], v[176:191]
    v_and_b32 v6, 0xffff0000, v25
    buffer_load_dwordx4 v[48:51], v2, s[32:35], s61 offen sc1
    v_mfma_f32_32x32x16_bf16 v[192:207], a[80:83], v[116:119], v[192:207]
    v_add_f32 v234, v234, v5
    v_mfma_f32_32x32x16_bf16 v[208:223], a[84:87], v[116:119], v[208:223]
    v_add_f32 v235, v235, v6
    buffer_load_dwordx4 v[52:55], v2, s[32:35], s61 offen offset:1024 sc1
    v_mfma_f32_32x32x16_bf16 v[160:175], a[88:91], v[120:123], v[160:175]
    v_lshlrev_b32 v236, 16, v18
    v_mfma_f32_32x32x16_bf16 v[176:191], a[92:95], v[120:123], v[176:191]
    v_and_b32 v237, 0xffff0000, v18
    buffer_load_dwordx4 v[56:59], v2, s[32:35], s61 offen offset:2048 sc1
    v_mfma_f32_32x32x16_bf16 v[192:207], a[88:91], v[124:127], v[192:207]
    v_lshlrev_b32 v5, 16, v26
    v_mfma_f32_32x32x16_bf16 v[208:223], a[92:95], v[124:127], v[208:223]
    v_and_b32 v6, 0xffff0000, v26
    buffer_load_dwordx4 v[60:63], v2, s[32:35], s61 offen offset:3072 sc1
    s_add_u32 s61, s61, 4096
    s_waitcnt vmcnt(11)
    v_mfma_f32_32x32x16_bf16 v[160:175], a[96:99], v[128:131], v[160:175]
    v_add_f32 v236, v236, v5
    v_mfma_f32_32x32x16_bf16 v[176:191], a[100:103], v[128:131], v[176:191]
    v_add_f32 v237, v237, v6
    buffer_load_dwordx4 v[64:67], v2, s[32:35], s61 offen sc1
    s_waitcnt vmcnt(11)
    v_mfma_f32_32x32x16_bf16 v[192:207], a[96:99], v[132:135], v[192:207]
    v_lshlrev_b32 v238, 16, v19
    v_mfma_f32_32x32x16_bf16 v[208:223], a[100:103], v[132:135], v[208:223]
    v_and_b32 v239, 0xffff0000, v19
    buffer_load_dwordx4 v[68:71], v2, s[32:35], s61 offen offset:1024 sc1
    s_waitcnt vmcnt(11)
    v_mfma_f32_32x32x16_bf16 v[160:175], a[104:107], v[136:139], v[160:175]
    v_lshlrev_b32 v5, 16, v27
    v_mfma_f32_32x32x16_bf16 v[176:191], a[108:111], v[136:139], v[176:191]
    v_and_b32 v6, 0xffff0000, v27
    buffer_load_dwordx4 v[72:75], v2, s[32:35], s61 offen offset:2048 sc1
    s_waitcnt vmcnt(11)
    v_mfma_f32_32x32x16_bf16 v[192:207], a[104:107], v[140:143], v[192:207]
    v_add_f32 v238, v238, v5
    v_mfma_f32_32x32x16_bf16 v[208:223], a[108:111], v[140:143], v[208:223]
    v_add_f32 v239, v239, v6
    buffer_load_dwordx4 v[76:79], v2, s[32:35], s61 offen offset:3072 sc1
    s_add_u32 s61, s61, 4096
    s_waitcnt vmcnt(11)
    v_mfma_f32_32x32x16_bf16 v[160:175], a[112:115], v[32:35], v[160:175]
    v_mfma_f32_32x32x16_bf16 v[176:191], a[116:119], v[32:35], v[176:191]
    buffer_load_dwordx4 v[80:83], v2, s[32:35], s61 offen sc1
    s_waitcnt vmcnt(11)
    v_mfma_f32_32x32x16_bf16 v[192:207], a[112:115], v[36:39], v[192:207]
    v_mfma_f32_32x32x16_bf16 v[208:223], a[116:119], v[36:39], v[208:223]
    buffer_load_dwordx4 v[84:87], v2, s[32:35], s61 offen offset:1024 sc1
    s_waitcnt vmcnt(11)
    v_mfma_f32_32x32x16_bf16 v[160:175], a[120:123], v[40:43], v[160:175]
    v_mfma_f32_32x32x16_bf16 v[176:191], a[124:127], v[40:43], v[176:191]
    buffer_load_dwordx4 v[88:91], v2, s[32:35], s61 offen offset:2048 sc1
    s_waitcnt vmcnt(11)
    v_mfma_f32_32x32x16_bf16 v[192:207], a[120:123], v[44:47], v[192:207]
    v_mfma_f32_32x32x16_bf16 v[208:223], a[124:127], v[44:47], v[208:223]
    buffer_load_dwordx4 v[92:95], v2, s[32:35], s61 offen offset:3072 sc1
    s_add_u32 s61, s61, 4096
    s_waitcnt vmcnt(11)
    v_mfma_f32_32x32x16_bf16 v[160:175], a[128:131], v[48:51], v[160:175]
    v_mfma_f32_32x32x16_bf16 v[176:191], a[132:135], v[48:51], v[176:191]
    buffer_load_dwordx4 v[96:99], v2, s[32:35], s61 offen sc1
    s_waitcnt vmcnt(11)
    v_mfma_f32_32x32x16_bf16 v[192:207], a[128:131], v[52:55], v[192:207]
    v_mfma_f32_32x32x16_bf16 v[208:223], a[132:135], v[52:55], v[208:223]
    buffer_load_dwordx4 v[100:103], v2, s[32:35], s61 offen offset:1024 sc1
    s_waitcnt vmcnt(11)
    v_mfma_f32_32x32x16_bf16 v[160:175], a[136:139], v[56:59], v[160:175]
    v_mfma_f32_32x32x16_bf16 v[176:191], a[140:143], v[56:59], v[176:191]
    buffer_load_dwordx4 v[104:107], v2, s[32:35], s61 offen offset:2048 sc1
    s_waitcnt vmcnt(11)
    v_mfma_f32_32x32x16_bf16 v[192:207], a[136:139], v[60:63], v[192:207]
    v_mfma_f32_32x32x16_bf16 v[208:223], a[140:143], v[60:63], v[208:223]
    buffer_load_dwordx4 v[108:111], v2, s[32:35], s61 offen offset:3072 sc1
    s_add_u32 s61, s61, 4096
    s_waitcnt vmcnt(11)
    v_mfma_f32_32x32x16_bf16 v[160:175], a[144:147], v[64:67], v[160:175]
    v_mfma_f32_32x32x16_bf16 v[176:191], a[148:151], v[64:67], v[176:191]
    buffer_load_dwordx4 v[112:115], v2, s[32:35], s61 offen sc1
    s_waitcnt vmcnt(11)
    v_mfma_f32_32x32x16_bf16 v[192:207], a[144:147], v[68:71], v[192:207]
    v_mfma_f32_32x32x16_bf16 v[208:223], a[148:151], v[68:71], v[208:223]
    buffer_load_dwordx4 v[116:119], v2, s[32:35], s61 offen offset:1024 sc1
    s_waitcnt vmcnt(11)
    v_mfma_f32_32x32x16_bf16 v[160:175], a[152:155], v[72:75], v[160:175]
    v_mfma_f32_32x32x16_bf16 v[176:191], a[156:159], v[72:75], v[176:191]
    buffer_load_dwordx4 v[120:123], v2, s[32:35], s61 offen offset:2048 sc1
    s_waitcnt vmcnt(11)
    v_mfma_f32_32x32x16_bf16 v[192:207], a[152:155], v[76:79], v[192:207]
    v_mfma_f32_32x32x16_bf16 v[208:223], a[156:159], v[76:79], v[208:223]
    buffer_load_dwordx4 v[124:127], v2, s[32:35], s61 offen offset:3072 sc1
    s_add_u32 s61, s61, 4096
    s_waitcnt vmcnt(11)
    v_mfma_f32_32x32x16_bf16 v[160:175], a[160:163], v[80:83], v[160:175]
    v_mfma_f32_32x32x16_bf16 v[176:191], a[164:167], v[80:83], v[176:191]
    buffer_load_dwordx4 v[128:131], v2, s[32:35], s61 offen sc1
    s_waitcnt vmcnt(11)
    v_mfma_f32_32x32x16_bf16 v[192:207], a[160:163], v[84:87], v[192:207]
    v_mfma_f32_32x32x16_bf16 v[208:223], a[164:167], v[84:87], v[208:223]
    buffer_load_dwordx4 v[132:135], v2, s[32:35], s61 offen offset:1024 sc1
    s_lshl_b32 s49, s47, 1
    s_add_u32 s49, s49, s53
    s_lshl_b32 s49, s49, 7
    s_add_u32 s49, s49, 0x1c000
    v_lshl_add_u32 v3, v10, 2, s49
    ds_read_b32 v29, v3
    s_xor_b32 s49, s44, 1
    s_mul_i32 s49, s49, 12288
    s_add_u32 s49, s49, 0x0
    v_add_u32 v241, s49, v2
    s_xor_b32 s49, s44, 2
    s_mul_i32 s49, s49, 12288
    s_add_u32 s49, s49, 0x1000
    v_add_u32 v242, s49, v2
    s_xor_b32 s49, s44, 3
    s_mul_i32 s49, s49, 12288
    s_add_u32 s49, s49, 0x2000
    v_add_u32 v243, s49, v2
    s_mul_i32 s49, s44, 12288
    v_add_u32 v240, s49, v2
    s_waitcnt vmcnt(11)
    v_mfma_f32_32x32x16_bf16 v[160:175], a[168:171], v[88:91], v[160:175]
    v_mfma_f32_32x32x16_bf16 v[176:191], a[172:175], v[88:91], v[176:191]
    buffer_load_dwordx4 v[136:139], v2, s[32:35], s61 offen offset:2048 sc1
    s_waitcnt vmcnt(11)
    v_mfma_f32_32x32x16_bf16 v[192:207], a[168:171], v[92:95], v[192:207]
    v_mfma_f32_32x32x16_bf16 v[208:223], a[172:175], v[92:95], v[208:223]
    buffer_load_dwordx4 v[140:143], v2, s[32:35], s61 offen offset:3072 sc1
    s_add_u32 s61, s61, 4096
    s_waitcnt vmcnt(11)
    v_mfma_f32_32x32x16_bf16 v[160:175], a[176:179], v[96:99], v[160:175]
    v_mfma_f32_32x32x16_bf16 v[176:191], a[180:183], v[96:99], v[176:191]
    s_waitcnt vmcnt(10)
    v_mfma_f32_32x32x16_bf16 v[192:207], a[176:179], v[100:103], v[192:207]
    v_mfma_f32_32x32x16_bf16 v[208:223], a[180:183], v[100:103], v[208:223]
    s_waitcnt vmcnt(9)
    v_mfma_f32_32x32x16_bf16 v[160:175], a[184:187], v[104:107], v[160:175]
    v_mfma_f32_32x32x16_bf16 v[176:191], a[188:191], v[104:107], v[176:191]
    s_waitcnt vmcnt(8)
    v_mfma_f32_32x32x16_bf16 v[192:207], a[184:187], v[108:111], v[192:207]
    v_mfma_f32_32x32x16_bf16 v[208:223], a[188:191], v[108:111], v[208:223]
    s_waitcnt vmcnt(7)
    v_mfma_f32_32x32x16_bf16 v[160:175], a[192:195], v[112:115], v[160:175]
    v_mfma_f32_32x32x16_bf16 v[176:191], a[196:199], v[112:115], v[176:191]
    s_waitcnt vmcnt(6)
    v_mfma_f32_32x32x16_bf16 v[192:207], a[192:195], v[116:119], v[192:207]
    v_mfma_f32_32x32x16_bf16 v[208:223], a[196:199], v[116:119], v[208:223]
    s_waitcnt vmcnt(4)
    v_mfma_f32_32x32x16_bf16 v[208:223], a[204:207], v[124:127], v[208:223]
    s_waitcnt vmcnt(2)
    v_mfma_f32_32x32x16_bf16 v[208:223], a[212:215], v[132:135], v[208:223]
    s_waitcnt vmcnt(0)
    v_mfma_f32_32x32x16_bf16 v[208:223], a[220:223], v[140:143], v[208:223]
    v_mfma_f32_32x32x16_bf16 v[192:207], a[200:203], v[124:127], v[192:207]
    v_mfma_f32_32x32x16_bf16 v[192:207], a[208:211], v[132:135], v[192:207]
    v_mfma_f32_32x32x16_bf16 v[192:207], a[216:219], v[140:143], v[192:207]
    s_nop 8
    ds_write_b128 v243, v[208:211]
    ds_write_b128 v243, v[212:215] offset:1024
    ds_write_b128 v243, v[216:219] offset:2048
    ds_write_b128 v243, v[220:223] offset:3072
    v_mfma_f32_32x32x16_bf16 v[176:191], a[204:207], v[120:123], v[176:191]
    v_mfma_f32_32x32x16_bf16 v[176:191], a[212:215], v[128:131], v[176:191]
    v_mfma_f32_32x32x16_bf16 v[176:191], a[220:223], v[136:139], v[176:191]
    ds_write_b128 v242, v[192:195]
    ds_write_b128 v242, v[196:199] offset:1024
    ds_write_b128 v242, v[200:203] offset:2048
    ds_write_b128 v242, v[204:207] offset:3072
    v_mfma_f32_32x32x16_bf16 v[160:175], a[200:203], v[120:123], v[160:175]
    v_mfma_f32_32x32x16_bf16 v[160:175], a[208:211], v[128:131], v[160:175]
    v_mfma_f32_32x32x16_bf16 v[160:175], a[216:219], v[136:139], v[160:175]
    s_nop 4
    ds_write_b128 v241, v[176:179]
    ds_write_b128 v241, v[180:183] offset:1024
    ds_write_b128 v241, v[184:187] offset:2048
    ds_write_b128 v241, v[188:191] offset:3072
    s_waitcnt lgkmcnt(0)
    s_barrier
    ds_read_b128 v[32:35], v240
    ds_read_b128 v[36:39], v240 offset:1024
    ds_read_b128 v[40:43], v240 offset:2048
    ds_read_b128 v[44:47], v240 offset:3072
    ds_read_b128 v[48:51], v240 offset:4096
    ds_read_b128 v[52:55], v240 offset:5120
    ds_read_b128 v[56:59], v240 offset:6144
    ds_read_b128 v[60:63], v240 offset:7168
    ds_read_b128 v[64:67], v240 offset:8192
    ds_read_b128 v[68:71], v240 offset:9216
    ds_read_b128 v[72:75], v240 offset:10240
    ds_read_b128 v[76:79], v240 offset:11264
    s_waitcnt lgkmcnt(11)
    v_pk_add_f32 v[160:161], v[160:161], v[32:33]
    v_pk_add_f32 v[162:163], v[162:163], v[34:35]
    s_waitcnt lgkmcnt(10)
    v_pk_add_f32 v[164:165], v[164:165], v[36:37]
    v_pk_add_f32 v[166:167], v[166:167], v[38:39]
    s_waitcnt lgkmcnt(9)
    v_pk_add_f32 v[168:169], v[168:169], v[40:41]
    v_pk_add_f32 v[170:171], v[170:171], v[42:43]
    s_waitcnt lgkmcnt(8)
    v_pk_add_f32 v[172:173], v[172:173], v[44:45]
    v_pk_add_f32 v[174:175], v[174:175], v[46:47]
    s_waitcnt lgkmcnt(7)
    v_pk_add_f32 v[160:161], v[160:161], v[48:49]
    v_pk_add_f32 v[162:163], v[162:163], v[50:51]
    s_waitcnt lgkmcnt(6)
    v_pk_add_f32 v[164:165], v[164:165], v[52:53]
    v_pk_add_f32 v[166:167], v[166:167], v[54:55]
    s_waitcnt lgkmcnt(5)
    v_pk_add_f32 v[168:169], v[168:169], v[56:57]
    v_pk_add_f32 v[170:171], v[170:171], v[58:59]
    s_waitcnt lgkmcnt(4)
    v_pk_add_f32 v[172:173], v[172:173], v[60:61]
    v_pk_add_f32 v[174:175], v[174:175], v[62:63]
    s_waitcnt lgkmcnt(3)
    v_pk_add_f32 v[160:161], v[160:161], v[64:65]
    v_pk_add_f32 v[162:163], v[162:163], v[66:67]
    s_waitcnt lgkmcnt(2)
    v_pk_add_f32 v[164:165], v[164:165], v[68:69]
    v_pk_add_f32 v[166:167], v[166:167], v[70:71]
    s_waitcnt lgkmcnt(1)
    v_pk_add_f32 v[168:169], v[168:169], v[72:73]
    v_pk_add_f32 v[170:171], v[170:171], v[74:75]
    s_waitcnt lgkmcnt(0)
    v_pk_add_f32 v[172:173], v[172:173], v[76:77]
    v_pk_add_f32 v[174:175], v[174:175], v[78:79]
    v_fma_f32 v224, v160, v29, v224
    v_fma_f32 v225, v161, v29, v225
    v_fma_f32 v226, v162, v29, v226
    v_fma_f32 v227, v163, v29, v227
    v_fma_f32 v228, v164, v29, v228
    v_fma_f32 v229, v165, v29, v229
    v_fma_f32 v230, v166, v29, v230
    v_fma_f32 v231, v167, v29, v231
    v_fma_f32 v232, v168, v29, v232
    v_fma_f32 v233, v169, v29, v233
    v_fma_f32 v234, v170, v29, v234
    v_fma_f32 v235, v171, v29, v235
    v_fma_f32 v236, v172, v29, v236
    v_fma_f32 v237, v173, v29, v237
    v_fma_f32 v238, v174, v29, v238
    v_fma_f32 v239, v175, v29, v239
    v_cvt_pk_bf16_f32 v176, v224, v225
    v_cvt_pk_bf16_f32 v177, v226, v227
    v_cvt_pk_bf16_f32 v178, v228, v229
    v_cvt_pk_bf16_f32 v179, v230, v231
    v_cvt_pk_bf16_f32 v180, v232, v233
    v_cvt_pk_bf16_f32 v181, v234, v235
    v_cvt_pk_bf16_f32 v182, v236, v237
    v_cvt_pk_bf16_f32 v183, v238, v239
    v_permlane32_swap_b32 v176, v178
    v_permlane32_swap_b32 v177, v179
    v_permlane32_swap_b32 v180, v182
    v_permlane32_swap_b32 v181, v183
    v_lshl_add_u32 v3, v9, 3, v8
    buffer_store_dwordx4 v[176:179], v3, s[36:39], s72 offen
    buffer_store_dwordx4 v[180:183], v3, s[36:39], s72 offen offset:32
K2_DONE:
    s_endpgm
K2_END:
.section .rodata,"a"
.p2align 6
.amdhsa_kernel k1_kernel
  .amdhsa_next_free_vgpr 168
  .amdhsa_next_free_sgpr 102
  .amdhsa_accum_offset 168
  .amdhsa_group_segment_fixed_size 0
  .amdhsa_kernarg_size 88
  .amdhsa_user_sgpr_count 2
  .amdhsa_user_sgpr_kernarg_segment_ptr 1
  .amdhsa_system_sgpr_workgroup_id_x 1
  .amdhsa_float_denorm_mode_32 3
.end_amdhsa_kernel
.p2align 6
.amdhsa_kernel k2_kernel
  .amdhsa_next_free_vgpr 512
  .amdhsa_next_free_sgpr 102
  .amdhsa_accum_offset 256
  .amdhsa_group_segment_fixed_size 0
  .amdhsa_kernarg_size 88
  .amdhsa_user_sgpr_count 2
  .amdhsa_user_sgpr_kernarg_segment_ptr 1
  .amdhsa_system_sgpr_workgroup_id_x 1
  .amdhsa_float_denorm_mode_32 3
.end_amdhsa_kernel
```
